```python
import torch

def _softmax(x, axis=-1):
    return torch.softmax(x, dim=axis)
def _gelu(x):
    return torch.nn.functional.gelu(x, approximate="tanh")
def _silu(x):
    return torch.nn.functional.silu(x)
def _sigmoid(x):
    return torch.sigmoid(x)
def _layernorm(x, axis=-1, eps=1e-5):
    m = x.mean(dim=axis, keepdim=True)
    v = x.var(dim=axis, keepdim=True, unbiased=False)
    return (x - m) / torch.sqrt(v + eps)
def _scatter_add(tgt, idx, src, axis=0):
    return tgt.clone().index_add_(axis, idx, src)
def _segment_sum(src, seg, n):
    out = torch.zeros((n,) + src.shape[1:], dtype=src.dtype)
    return out.index_add_(0, seg, src)
def _pad(x, pw):
    flat = tuple(v for pair in reversed(pw) for v in pair)
    return torch.nn.functional.pad(x, flat)

kernel_name = 'gated_mix__softmax_full_mha__mha_block__prompt'

def setup_inputs():

    _w = (lambda a: (lambda t: t.to(torch.bfloat16) if t.is_floating_point() else t)(torch.as_tensor(a)))
    def _A_setup():
        B, S, D = 1, 2048, 512
        return {
            "x": _w((lambda *s: torch.randn(*s, dtype=torch.bfloat16) * 0.05)(B, S, D)),
            "wqkv": _w((lambda *s: torch.randn(*s, dtype=torch.bfloat16) * 0.8)(D, 3 * D)),
            "wo": _w((lambda *s: torch.randn(*s, dtype=torch.bfloat16) * 0.05)(D, D)),
        }
    _A_in = _A_setup()

    def _B_setup():
        B, S, D, H = 1, 2048, 512, 32
        return {
            "x": _w((lambda *s: torch.randn(*s, dtype=torch.bfloat16) * 0.05)(B, S, D)),
            "wqkv": _w((lambda *s: torch.randn(*s, dtype=torch.bfloat16) * 0.8)(D, 3 * D)),
            "wo": _w((lambda *s: torch.randn(*s, dtype=torch.bfloat16) * 0.05)(D, D)),
        }
    _B_in = _B_setup()

    return {
        "A_x": _A_in["x"],
        "A_wqkv": _A_in["wqkv"],
        "A_wo": _A_in["wo"],
        "B_x": _B_in["x"],
        "B_wqkv": _B_in["wqkv"],
        "B_wo": _B_in["wo"],
        "gate_w": _w((lambda *s: torch.randn(*s, dtype=torch.bfloat16) * 0.05)(512) * 16.0),
    }

def reference(A_x, A_wqkv, A_wo, B_x, B_wqkv, B_wo, gate_w):
    def _A_ref(x, wqkv, wo):
        B, S, D = x.shape
        H = 32; Dh = D // H
        qkv = (lambda x, *d: x.permute(*d))((x @ wqkv).reshape(B, S, 3, H, Dh), 2, 0, 3, 1, 4)
        q, k, v = qkv[0], qkv[1], qkv[2]
        scale = Dh ** -0.5
        scores = torch.einsum("bhqd,bhkd->bhqk", q, k) * scale
        p = _softmax(scores, axis=-1)
        o = torch.einsum("bhqk,bhkd->bhqd", p, v)
        return (lambda x, *d: x.permute(*d))(o, 0, 2, 1, 3).reshape(B, S, D) @ wo

    def _B_ref(x, wqkv, wo):
        B, S, D = x.shape
        H = 32
        Dh = D // H
        qkv = (lambda x, *d: x.permute(*d))((x @ wqkv).reshape(B, S, 3, H, Dh), 2, 0, 3, 1, 4)
        q, k, v = qkv[0], qkv[1], qkv[2]
        scores = torch.einsum("bhqd,bhkd->bhqk", q, k) * (Dh ** -0.5)
        p = _softmax(scores, axis=-1)
        o = torch.einsum("bhqk,bhkd->bhqd", p, v)
        return (lambda x, *d: x.permute(*d))(o, 0, 2, 1, 3).reshape(B, S, D) @ wo

    x = A_x
    g = _sigmoid((x * gate_w).sum(-1, keepdims=True))
    a = _A_ref(x, A_wqkv, A_wo)
    b = _B_ref(x, B_wqkv, B_wo)
    return g * a + (1 - g) * b
```

```asm
; @launch grid=(256,1,1) block=(512,1,1) lds=163840
.amdgcn_target "amdgcn-amd-amdhsa--gfx950"
.text
.globl gated_mix__softmax_full_mha__mha_block__prompt_kernel
.p2align 8
.type gated_mix__softmax_full_mha__mha_block__prompt_kernel,@function
gated_mix__softmax_full_mha__mha_block__prompt_kernel:
  s_cmp_ge_u32 s2, 256
  s_cbranch_scc1 L_END
  s_load_dwordx16 s[36:51], s[0:1], 0
  s_load_dwordx4 s[52:55], s[0:1], 64
  v_lshrrev_b32 v1, 6, v0
  v_and_b32 v0, 63, v0
  s_and_b32 s60, s2, 7
  v_readfirstlane_b32 s56, v1
  s_lshr_b32 s61, s2, 3
  s_and_b32 s58, s61, 7
  s_lshr_b32 s61, s61, 3
  s_lshl_b32 s62, s60, 2
  s_add_u32 s57, s62, s61
  s_lshl_b32 s61, s61, 1
  s_mov_b32 s59, s60
  s_add_u32 s59, s59, s58
  s_add_u32 s59, s59, s61
  s_and_b32 s59, s59, 7
  s_and_b32 s69, s56, 3
  s_lshr_b32 s68, s56, 2
  s_cbranch_scc0 L_COMPUTE
  s_lshl_b32 s60, s58, 2
  s_add_u32 s60, s60, s69
  s_lshl_b32 s60, s60, 16
  v_lshrrev_b32 v1, 3, v0
  v_lshl_add_u32 v1, v1, 10, s60
  v_lshrrev_b32 v2, 4, v0
  v_xor_b32 v2, v2, v0
  v_and_b32 v2, 7, v2
  v_lshl_add_u32 v8, v2, 4, v1
  v_xor_b32 v9, 64, v8
  v_add_u32 v9, 0x2000, v9
  v_lshrrev_b32 v10, 2, v0
  v_mul_u32_u24 v10, 0xc00, v10
  v_and_b32 v5, 3, v0
  v_lshl_add_u32 v10, v5, 4, v10
  s_mul_i32 s61, s69, 0xc000
  s_and_b32 s62, s57, 15
  s_lshl_b32 s62, s62, 6
  s_add_u32 s61, s61, s62
  v_add_u32 v10, s61, v10
  s_lshl_b32 s94, s69, 13
  s_lshl_b32 s95, s69, 10
  s_add_u32 s95, s95, 0x8000
  s_lshl_b32 s96, s59, 7
  s_mul_i32 s97, s59, 196608
  s_mov_b32 s6, 0x200000
  s_mov_b32 s7, 0x20000
  s_mov_b32 s10, 0x180000
  s_mov_b32 s11, 0x20000
  s_cmp_lt_u32 s57, 16
  s_waitcnt lgkmcnt(0)
  s_cselect_b32 s8, s38, s44
  s_cselect_b32 s9, s39, s45
  s_mov_b32 s4, s36
  s_mov_b32 s5, s37
  s_add_u32 m0, s95, 0
  s_add_u32 s63, s97, 0
  buffer_load_dwordx4 v10, s[8:11], s63 offen lds
  s_add_u32 m0, s95, 4096
  s_add_u32 s63, s97, 1024
  buffer_load_dwordx4 v10, s[8:11], s63 offen lds
  s_add_u32 m0, s95, 8192
  s_add_u32 s63, s97, 2048
  buffer_load_dwordx4 v10, s[8:11], s63 offen lds
  s_add_u32 m0, s94, 0
  s_add_u32 s63, s96, 0
  buffer_load_dwordx4 v8, s[4:7], s63 offen lds
  s_add_u32 m0, s94, 1024
  s_add_u32 s63, s96, 0
  buffer_load_dwordx4 v9, s[4:7], s63 offen lds
  s_add_u32 m0, s94, 2048
  s_add_u32 s63, s96, 16384
  buffer_load_dwordx4 v8, s[4:7], s63 offen lds
  s_add_u32 m0, s94, 3072
  s_add_u32 s63, s96, 16384
  buffer_load_dwordx4 v9, s[4:7], s63 offen lds
  s_add_u32 m0, s94, 4096
  s_add_u32 s63, s96, 32768
  buffer_load_dwordx4 v8, s[4:7], s63 offen lds
  s_add_u32 m0, s94, 5120
  s_add_u32 s63, s96, 32768
  buffer_load_dwordx4 v9, s[4:7], s63 offen lds
  s_add_u32 m0, s94, 6144
  s_add_u32 s63, s96, 49152
  buffer_load_dwordx4 v8, s[4:7], s63 offen lds
  s_add_u32 m0, s94, 7168
  s_add_u32 s63, s96, 49152
  buffer_load_dwordx4 v9, s[4:7], s63 offen lds
  s_add_u32 s96, s96, 128
  s_and_b32 s96, s96, 0x3ff
  s_add_u32 s97, s97, 196608
  s_cmp_eq_u32 s96, 0
  s_cselect_b32 s97, 0, s97
  s_add_u32 m0, s95, 45056
  s_add_u32 s63, s97, 0
  buffer_load_dwordx4 v10, s[8:11], s63 offen lds
  s_mov_b32 s16, s48
  s_mov_b32 s17, s49
  s_mov_b32 s18, 0x400
  s_mov_b32 s19, 0x20000
  s_mov_b32 s12, s54
  s_mov_b32 s13, s55
  s_mov_b32 s14, 0x1016000
  s_mov_b32 s15, 0x20000
  s_mov_b32 s20, s52
  s_mov_b32 s21, s53
  s_mov_b32 s22, 0x100
  s_mov_b32 s23, 0x20000
  s_add_u32 m0, s95, 49152
  s_add_u32 s63, s97, 1024
  buffer_load_dwordx4 v10, s[8:11], s63 offen lds
  s_mov_b32 s24, s50
  s_mov_b32 s25, s51
  s_mov_b32 s26, 0x200000
  s_mov_b32 s27, 0x20000
  s_add_u32 m0, s95, 53248
  s_add_u32 s63, s97, 2048
  buffer_load_dwordx4 v10, s[8:11], s63 offen lds
  s_and_b32 s60, s58, 1
  s_lshl_b32 s60, s60, 2
  s_and_b32 s61, s57, 3
  s_add_u32 s33, s60, s61
  s_add_u32 m0, s94, 45056
  s_add_u32 s63, s96, 0
  buffer_load_dwordx4 v8, s[4:7], s63 offen lds
  s_cmp_eq_u32 s33, 7
  s_cselect_b32 s59, 0, s33
  s_mov_b32 s59, 0
  s_lshr_b32 s34, s57, 2
  s_and_b32 s59, s34, 1
  s_lshl_b32 s59, s59, 2
  s_lshr_b32 s60, s34, 1
  s_add_u32 s59, s59, s60
  s_add_u32 m0, s94, 46080
  s_add_u32 s63, s96, 0
  buffer_load_dwordx4 v9, s[4:7], s63 offen lds
  s_lshl_b32 s60, s69, 1
  s_add_u32 s60, s60, s68
  s_lshl_b32 s49, s60, 14
  s_lshl_b32 s32, s56, 13
  s_add_u32 s32, s32, 0x8000
  s_lshl_b32 s48, s56, 12
  s_add_u32 s48, s48, 122880
  s_add_u32 m0, s94, 47104
  s_add_u32 s63, s96, 16384
  buffer_load_dwordx4 v8, s[4:7], s63 offen lds
  s_and_b32 s60, s57, 28
  s_lshr_b32 s62, s58, 1
  s_add_u32 s35, s60, s62
  s_lshr_b32 s61, s49, 3
  s_lshl_b32 s60, s35, 17
  s_add_u32 s61, s61, s60
  s_add_u32 s61, s61, 12582912
  s_mov_b32 s55, 0
  s_add_u32 m0, s94, 48128
  s_add_u32 s63, s96, 16384
  buffer_load_dwordx4 v9, s[4:7], s63 offen lds
  s_mov_b32 s60, 0
  s_cmp_ge_u32 s60, s59
  s_addc_u32 s60, s60, 0
  s_lshr_b32 s64, s60, 2
  s_lshl_b32 s60, s60, 1
  s_and_b32 s60, s60, 6
  s_add_u32 s60, s60, s64
  s_lshl_b32 s62, s60, 0
  s_or_b32 s55, s55, s62
  s_lshl_b32 s60, s60, 14
  s_add_u32 s42, s60, s61
  s_add_u32 m0, s94, 49152
  s_add_u32 s63, s96, 32768
  buffer_load_dwordx4 v8, s[4:7], s63 offen lds
  s_mov_b32 s60, 1
  s_cmp_ge_u32 s60, s59
  s_addc_u32 s60, s60, 0
  s_lshr_b32 s64, s60, 2
  s_lshl_b32 s60, s60, 1
  s_and_b32 s60, s60, 6
  s_add_u32 s60, s60, s64
  s_lshl_b32 s62, s60, 4
  s_or_b32 s55, s55, s62
  s_lshl_b32 s60, s60, 14
  s_add_u32 s43, s60, s61
  v_lshlrev_b32 v4, 4, v0
  v_mov_b32 v29, 0
  v_mov_b32 v30, 1
  s_waitcnt vmcnt(8)
  s_barrier
  s_add_u32 m0, s94, 50176
  s_add_u32 s63, s96, 32768
  buffer_load_dwordx4 v9, s[4:7], s63 offen lds
  s_mov_b32 s60, 2
  s_cmp_ge_u32 s60, s59
  s_addc_u32 s60, s60, 0
  s_lshr_b32 s64, s60, 2
  s_lshl_b32 s60, s60, 1
  s_and_b32 s60, s60, 6
  s_add_u32 s60, s60, s64
  s_lshl_b32 s62, s60, 8
  s_or_b32 s55, s55, s62
  s_lshl_b32 s60, s60, 14
  s_add_u32 s44, s60, s61
  s_add_u32 m0, s94, 51200
  s_add_u32 s63, s96, 49152
  buffer_load_dwordx4 v8, s[4:7], s63 offen lds
  s_mov_b32 s60, 3
  s_cmp_ge_u32 s60, s59
  s_addc_u32 s60, s60, 0
  s_lshr_b32 s64, s60, 2
  s_lshl_b32 s60, s60, 1
  s_and_b32 s60, s60, 6
  s_add_u32 s60, s60, s64
  s_lshl_b32 s62, s60, 12
  s_or_b32 s55, s55, s62
  s_lshl_b32 s60, s60, 14
  s_add_u32 s45, s60, s61
  s_add_u32 m0, s94, 52224
  s_add_u32 s63, s96, 49152
  buffer_load_dwordx4 v9, s[4:7], s63 offen lds
  s_mov_b32 s60, 4
  s_cmp_ge_u32 s60, s59
  s_addc_u32 s60, s60, 0
  s_lshr_b32 s64, s60, 2
  s_lshl_b32 s60, s60, 1
  s_and_b32 s60, s60, 6
  s_add_u32 s60, s60, s64
  s_lshl_b32 s62, s60, 16
  s_or_b32 s55, s55, s62
  s_lshl_b32 s60, s60, 14
  s_add_u32 s50, s60, s61
  s_add_u32 s96, s96, 128
  s_and_b32 s96, s96, 0x3ff
  s_add_u32 s97, s97, 196608
  s_cmp_eq_u32 s96, 0
  s_cselect_b32 s97, 0, s97
  s_add_u32 m0, s95, 90112
  s_add_u32 s63, s97, 0
  buffer_load_dwordx4 v10, s[8:11], s63 offen lds
  s_mov_b32 s60, 5
  s_cmp_ge_u32 s60, s59
  s_addc_u32 s60, s60, 0
  s_lshr_b32 s64, s60, 2
  s_lshl_b32 s60, s60, 1
  s_and_b32 s60, s60, 6
  s_add_u32 s60, s60, s64
  s_lshl_b32 s62, s60, 20
  s_or_b32 s55, s55, s62
  s_lshl_b32 s60, s60, 14
  s_add_u32 s51, s60, s61
  s_add_u32 m0, s95, 94208
  s_add_u32 s63, s97, 1024
  buffer_load_dwordx4 v10, s[8:11], s63 offen lds
  s_mov_b32 s60, 6
  s_cmp_ge_u32 s60, s59
  s_addc_u32 s60, s60, 0
  s_lshr_b32 s64, s60, 2
  s_lshl_b32 s60, s60, 1
  s_and_b32 s60, s60, 6
  s_add_u32 s60, s60, s64
  s_mov_b32 s38, s60
  s_lshl_b32 s60, s60, 14
  s_add_u32 s52, s60, s61
  s_add_u32 m0, s95, 98304
  s_add_u32 s63, s97, 2048
  buffer_load_dwordx4 v10, s[8:11], s63 offen lds
  s_mov_b32 s60, s34
  s_mov_b32 s39, s60
  s_lshl_b32 s60, s60, 14
  s_add_u32 s53, s60, s61
  s_add_u32 m0, s94, 90112
  s_add_u32 s63, s96, 0
  buffer_load_dwordx4 v8, s[4:7], s63 offen lds
  s_mov_b32 s60, 0x3fb8aa3b
  s_mov_b32 s61, 0xbfb8aa3b
  s_cmp_lt_u32 s57, 16
  s_cselect_b32 s37, s61, s60
  s_lshl_b32 s36, s33, 7
  s_lshl_b32 s60, s69, 5
  s_add_u32 s36, s36, s60
  s_add_u32 m0, s94, 91136
  s_add_u32 s63, s96, 0
  buffer_load_dwordx4 v9, s[4:7], s63 offen lds
  s_lshl_b32 s60, s58, 2
  s_lshr_b32 s61, s57, 3
  s_add_u32 s61, s61, s60
  s_lshl_b32 s61, s61, 8
  s_add_u32 s54, s61, 16842752
  s_add_u32 s60, s60, s69
  s_lshl_b32 s60, s60, 8
  s_add_u32 s0, s60, 16859136
  s_lshr_b32 s60, s35, 2
  s_lshl_b32 s60, s60, 10
  s_add_u32 s1, s60, 16842752
  s_mov_b32 s30, 0x80000
  s_mov_b32 s31, 0x20000
  s_add_u32 m0, s94, 92160
  s_add_u32 s63, s96, 16384
  buffer_load_dwordx4 v8, s[4:7], s63 offen lds
  s_add_u32 m0, s94, 93184
  s_add_u32 s63, s96, 16384
  buffer_load_dwordx4 v9, s[4:7], s63 offen lds
  s_add_u32 m0, s94, 94208
  s_add_u32 s63, s96, 32768
  buffer_load_dwordx4 v8, s[4:7], s63 offen lds
  s_add_u32 m0, s94, 95232
  s_add_u32 s63, s96, 32768
  buffer_load_dwordx4 v9, s[4:7], s63 offen lds
  s_add_u32 m0, s94, 96256
  s_add_u32 s63, s96, 49152
  buffer_load_dwordx4 v8, s[4:7], s63 offen lds
  s_add_u32 m0, s94, 97280
  s_add_u32 s63, s96, 49152
  buffer_load_dwordx4 v9, s[4:7], s63 offen lds
  s_add_u32 s96, s96, 128
  s_and_b32 s96, s96, 0x3ff
  s_add_u32 s97, s97, 196608
  s_cmp_eq_u32 s96, 0
  s_cselect_b32 s97, 0, s97
  s_waitcnt vmcnt(11)
  s_barrier
  s_add_u32 m0, s95, 0
  s_add_u32 s63, s97, 0
  buffer_load_dwordx4 v10, s[8:11], s63 offen lds
  s_add_u32 m0, s95, 4096
  s_add_u32 s63, s97, 1024
  buffer_load_dwordx4 v10, s[8:11], s63 offen lds
  s_add_u32 m0, s95, 8192
  s_add_u32 s63, s97, 2048
  buffer_load_dwordx4 v10, s[8:11], s63 offen lds
  s_add_u32 m0, s94, 0
  s_add_u32 s63, s96, 0
  buffer_load_dwordx4 v8, s[4:7], s63 offen lds
  s_add_u32 m0, s94, 1024
  s_add_u32 s63, s96, 0
  buffer_load_dwordx4 v9, s[4:7], s63 offen lds
  s_add_u32 m0, s94, 2048
  s_add_u32 s63, s96, 16384
  buffer_load_dwordx4 v8, s[4:7], s63 offen lds
  s_add_u32 m0, s94, 3072
  s_add_u32 s63, s96, 16384
  buffer_load_dwordx4 v9, s[4:7], s63 offen lds
  s_add_u32 m0, s94, 4096
  s_add_u32 s63, s96, 32768
  buffer_load_dwordx4 v8, s[4:7], s63 offen lds
  s_add_u32 m0, s94, 5120
  s_add_u32 s63, s96, 32768
  buffer_load_dwordx4 v9, s[4:7], s63 offen lds
  s_add_u32 m0, s94, 6144
  s_add_u32 s63, s96, 49152
  buffer_load_dwordx4 v8, s[4:7], s63 offen lds
  s_add_u32 m0, s94, 7168
  s_add_u32 s63, s96, 49152
  buffer_load_dwordx4 v9, s[4:7], s63 offen lds
  s_add_u32 s96, s96, 128
  s_and_b32 s96, s96, 0x3ff
  s_add_u32 s97, s97, 196608
  s_cmp_eq_u32 s96, 0
  s_cselect_b32 s97, 0, s97
  s_waitcnt vmcnt(11)
  s_barrier
  s_add_u32 m0, s95, 45056
  s_add_u32 s63, s97, 0
  buffer_load_dwordx4 v10, s[8:11], s63 offen lds
  s_add_u32 m0, s95, 49152
  s_add_u32 s63, s97, 1024
  buffer_load_dwordx4 v10, s[8:11], s63 offen lds
  s_add_u32 m0, s95, 53248
  s_add_u32 s63, s97, 2048
  buffer_load_dwordx4 v10, s[8:11], s63 offen lds
  s_add_u32 m0, s94, 45056
  s_add_u32 s63, s96, 0
  buffer_load_dwordx4 v8, s[4:7], s63 offen lds
  s_add_u32 m0, s94, 46080
  s_add_u32 s63, s96, 0
  buffer_load_dwordx4 v9, s[4:7], s63 offen lds
  s_add_u32 m0, s94, 47104
  s_add_u32 s63, s96, 16384
  buffer_load_dwordx4 v8, s[4:7], s63 offen lds
  s_add_u32 m0, s94, 48128
  s_add_u32 s63, s96, 16384
  buffer_load_dwordx4 v9, s[4:7], s63 offen lds
  s_add_u32 m0, s94, 49152
  s_add_u32 s63, s96, 32768
  buffer_load_dwordx4 v8, s[4:7], s63 offen lds
  s_add_u32 m0, s94, 50176
  s_add_u32 s63, s96, 32768
  buffer_load_dwordx4 v9, s[4:7], s63 offen lds
  s_add_u32 m0, s94, 51200
  s_add_u32 s63, s96, 49152
  buffer_load_dwordx4 v8, s[4:7], s63 offen lds
  s_add_u32 m0, s94, 52224
  s_add_u32 s63, s96, 49152
  buffer_load_dwordx4 v9, s[4:7], s63 offen lds
  s_add_u32 s96, s96, 128
  s_and_b32 s96, s96, 0x3ff
  s_add_u32 s97, s97, 196608
  s_cmp_eq_u32 s96, 0
  s_cselect_b32 s97, 0, s97
  s_waitcnt vmcnt(11)
  s_barrier
  s_add_u32 m0, s95, 90112
  s_add_u32 s63, s97, 0
  buffer_load_dwordx4 v10, s[8:11], s63 offen lds
  s_add_u32 m0, s95, 94208
  s_add_u32 s63, s97, 1024
  buffer_load_dwordx4 v10, s[8:11], s63 offen lds
  s_add_u32 m0, s95, 98304
  s_add_u32 s63, s97, 2048
  buffer_load_dwordx4 v10, s[8:11], s63 offen lds
  s_add_u32 m0, s94, 90112
  s_add_u32 s63, s96, 0
  buffer_load_dwordx4 v8, s[4:7], s63 offen lds
  s_add_u32 m0, s94, 91136
  s_add_u32 s63, s96, 0
  buffer_load_dwordx4 v9, s[4:7], s63 offen lds
  s_add_u32 m0, s94, 92160
  s_add_u32 s63, s96, 16384
  buffer_load_dwordx4 v8, s[4:7], s63 offen lds
  s_add_u32 m0, s94, 93184
  s_add_u32 s63, s96, 16384
  buffer_load_dwordx4 v9, s[4:7], s63 offen lds
  s_add_u32 m0, s94, 94208
  s_add_u32 s63, s96, 32768
  buffer_load_dwordx4 v8, s[4:7], s63 offen lds
  s_add_u32 m0, s94, 95232
  s_add_u32 s63, s96, 32768
  buffer_load_dwordx4 v9, s[4:7], s63 offen lds
  s_add_u32 m0, s94, 96256
  s_add_u32 s63, s96, 49152
  buffer_load_dwordx4 v8, s[4:7], s63 offen lds
  s_add_u32 m0, s94, 97280
  s_add_u32 s63, s96, 49152
  buffer_load_dwordx4 v9, s[4:7], s63 offen lds
  s_add_u32 s96, s96, 128
  s_and_b32 s96, s96, 0x3ff
  s_add_u32 s97, s97, 196608
  s_cmp_eq_u32 s96, 0
  s_cselect_b32 s97, 0, s97
  s_waitcnt vmcnt(11)
  s_barrier
  s_add_u32 m0, s95, 0
  s_add_u32 s63, s97, 0
  buffer_load_dwordx4 v10, s[8:11], s63 offen lds
  s_add_u32 m0, s95, 4096
  s_add_u32 s63, s97, 1024
  buffer_load_dwordx4 v10, s[8:11], s63 offen lds
  s_add_u32 m0, s95, 8192
  s_add_u32 s63, s97, 2048
  buffer_load_dwordx4 v10, s[8:11], s63 offen lds
  s_add_u32 m0, s94, 0
  s_add_u32 s63, s96, 0
  buffer_load_dwordx4 v8, s[4:7], s63 offen lds
  s_add_u32 m0, s94, 1024
  s_add_u32 s63, s96, 0
  buffer_load_dwordx4 v9, s[4:7], s63 offen lds
  s_add_u32 m0, s94, 2048
  s_add_u32 s63, s96, 16384
  buffer_load_dwordx4 v8, s[4:7], s63 offen lds
  s_add_u32 m0, s94, 3072
  s_add_u32 s63, s96, 16384
  buffer_load_dwordx4 v9, s[4:7], s63 offen lds
  s_add_u32 m0, s94, 4096
  s_add_u32 s63, s96, 32768
  buffer_load_dwordx4 v8, s[4:7], s63 offen lds
  s_add_u32 m0, s94, 5120
  s_add_u32 s63, s96, 32768
  buffer_load_dwordx4 v9, s[4:7], s63 offen lds
  s_add_u32 m0, s94, 6144
  s_add_u32 s63, s96, 49152
  buffer_load_dwordx4 v8, s[4:7], s63 offen lds
  s_add_u32 m0, s94, 7168
  s_add_u32 s63, s96, 49152
  buffer_load_dwordx4 v9, s[4:7], s63 offen lds
  s_add_u32 s96, s96, 128
  s_and_b32 s96, s96, 0x3ff
  s_add_u32 s97, s97, 196608
  s_cmp_eq_u32 s96, 0
  s_cselect_b32 s97, 0, s97
  s_waitcnt vmcnt(11)
  s_barrier
  s_add_u32 m0, s95, 45056
  s_add_u32 s63, s97, 0
  buffer_load_dwordx4 v10, s[8:11], s63 offen lds
  s_add_u32 m0, s95, 49152
  s_add_u32 s63, s97, 1024
  buffer_load_dwordx4 v10, s[8:11], s63 offen lds
  s_add_u32 m0, s95, 53248
  s_add_u32 s63, s97, 2048
  buffer_load_dwordx4 v10, s[8:11], s63 offen lds
  s_add_u32 m0, s94, 45056
  s_add_u32 s63, s96, 0
  buffer_load_dwordx4 v8, s[4:7], s63 offen lds
  s_add_u32 m0, s94, 46080
  s_add_u32 s63, s96, 0
  buffer_load_dwordx4 v9, s[4:7], s63 offen lds
  s_add_u32 m0, s94, 47104
  s_add_u32 s63, s96, 16384
  buffer_load_dwordx4 v8, s[4:7], s63 offen lds
  s_add_u32 m0, s94, 48128
  s_add_u32 s63, s96, 16384
  buffer_load_dwordx4 v9, s[4:7], s63 offen lds
  s_add_u32 m0, s94, 49152
  s_add_u32 s63, s96, 32768
  buffer_load_dwordx4 v8, s[4:7], s63 offen lds
  s_add_u32 m0, s94, 50176
  s_add_u32 s63, s96, 32768
  buffer_load_dwordx4 v9, s[4:7], s63 offen lds
  s_add_u32 m0, s94, 51200
  s_add_u32 s63, s96, 49152
  buffer_load_dwordx4 v8, s[4:7], s63 offen lds
  s_add_u32 m0, s94, 52224
  s_add_u32 s63, s96, 49152
  buffer_load_dwordx4 v9, s[4:7], s63 offen lds
  s_lshl_b32 s96, s58, 8
  s_lshl_b32 s60, s57, 3
  s_add_u32 s96, s96, s60
  s_lshl_b32 s60, s69, 1
  s_add_u32 s96, s96, s60
  s_lshl_b32 s60, s96, 10
  buffer_load_dwordx4 v[16:19], v4, s[4:7], s60 offen
  buffer_load_dwordx4 v[20:23], v4, s[4:7], s60 offen offset:1024
  buffer_load_dwordx4 v[24:27], v4, s[16:19], 0 offen
  buffer_load_dword v14, v29, s[20:23], 0 offen sc1
  s_waitcnt vmcnt(15)
  s_barrier
  s_lshl_b32 s60, s68, 14
  v_add_u32 v2, s60, v4
  v_lshrrev_b32 v5, 5, v0
  v_and_b32 v3, 15, v0
  v_lshlrev_b32 v3, 4, v3
  v_lshl_add_u32 v3, v5, 8, v3
  v_add_u32 v3, 0x400, v3
  v_add_u32 v3, s60, v3
  v_mov_b32 v7, 0xdddddddd
  v_and_b32 v5, 27, v0
  v_cmp_eq_u32 vcc, 16, v5
  v_mov_b32 v5, 0x3f803f80
  v_mov_b32 v29, 0
  v_cndmask_b32 v176, 0, v5, vcc
  v_mov_b32 v177, v176
  v_mov_b32 v178, v176
  v_mov_b32 v179, v176
  v_mov_b32 v180, v176
  v_mov_b32 v181, v176
  v_mov_b32 v182, v176
  v_mov_b32 v183, v176
  v_mov_b32 v184, v176
  v_mov_b32 v185, v176
  v_mov_b32 v186, v176
  v_mov_b32 v187, v176
  v_mov_b32 v188, v176
  v_mov_b32 v189, v176
  v_mov_b32 v190, v176
  v_mov_b32 v191, v176
  v_mov_b32 v224, 0
  v_mov_b32 v225, 0
  v_mov_b32 v226, 0
  v_mov_b32 v227, 0
  v_mov_b32 v228, 0
  v_mov_b32 v229, 0
  v_mov_b32 v230, 0
  v_mov_b32 v231, 0
  v_mov_b32 v232, 0
  v_mov_b32 v233, 0
  v_mov_b32 v234, 0
  v_mov_b32 v235, 0
  v_mov_b32 v236, 0
  v_mov_b32 v237, 0
  v_mov_b32 v238, 0
  v_mov_b32 v239, 0
  v_mov_b32 v240, 0
  v_mov_b32 v241, 0
  v_mov_b32 v242, 0
  v_mov_b32 v243, 0
  v_mov_b32 v244, 0
  v_mov_b32 v245, 0
  v_mov_b32 v246, 0
  v_mov_b32 v247, 0
  v_mov_b32 v248, 0
  v_mov_b32 v249, 0
  v_mov_b32 v250, 0
  v_mov_b32 v251, 0
  v_mov_b32 v252, 0
  v_mov_b32 v253, 0
  v_mov_b32 v254, 0
  v_mov_b32 v255, 0
  v_mov_b32 v208, 0
  v_mov_b32 v209, 0
  v_mov_b32 v210, 0
  v_mov_b32 v211, 0
  v_mov_b32 v212, 0
  v_mov_b32 v213, 0
  v_mov_b32 v214, 0
  v_mov_b32 v215, 0
  v_mov_b32 v216, 0
  v_mov_b32 v217, 0
  v_mov_b32 v218, 0
  v_mov_b32 v219, 0
  v_mov_b32 v220, 0
  v_mov_b32 v221, 0
  v_mov_b32 v222, 0
  v_mov_b32 v223, 0
  v_mov_b32 v30, 1
  v_mov_b32 v31, 0
  s_mov_b32 s66, 0x0000ffff
  s_mov_b32 s67, 0x0000ffff
  v_lshrrev_b32 v28, 3, v0
  v_lshlrev_b32 v28, 10, v28
  v_lshrrev_b32 v5, 2, v0
  v_and_b32 v5, 4, v5
  v_xor_b32 v5, v5, v0
  v_and_b32 v5, 7, v5
  v_lshl_add_u32 v28, v5, 4, v28
  v_bfe_u32 v6, v0, 2, 2
  v_lshrrev_b32 v1, 5, v0
  v_lshl_add_u32 v6, v1, 2, v6
  v_bfe_u32 v5, v0, 4, 1
  v_and_b32 v1, 1, v0
  v_lshl_or_b32 v5, v5, 1, v1
  v_bfe_u32 v1, v0, 3, 1
  v_lshl_or_b32 v5, v1, 2, v5
  s_lshl_b32 s60, s69, 1
  v_xor_b32 v5, s60, v5
  v_lshlrev_b32 v5, 4, v5
  v_lshl_add_u32 v6, v6, 7, v5
  v_bfe_u32 v1, v0, 1, 1
  v_lshl_add_u32 v6, v1, 3, v6
  v_add_u32 v6, s32, v6
  s_lshl_b32 s60, s33, 7
  v_add_u32 v28, s60, v28
  s_waitcnt vmcnt(8)
  s_barrier
  s_waitcnt vmcnt(4)
  s_barrier
  s_waitcnt vmcnt(0)
  v_mov_b32 v12, 0
  v_mov_b32 v13, 0
  s_nop 1
  v_dot2_f32_bf16 v12, v16, v24, v12
  v_dot2_f32_bf16 v13, v20, v24, v13
  v_dot2_f32_bf16 v12, v17, v25, v12
  v_dot2_f32_bf16 v13, v21, v25, v13
  v_dot2_f32_bf16 v12, v18, v26, v12
  v_dot2_f32_bf16 v13, v22, v26, v13
  v_dot2_f32_bf16 v12, v19, v27, v12
  v_dot2_f32_bf16 v13, v23, v27, v13
  s_nop 3
  v_add_f32_dpp v12, v12, v12 row_ror:8 row_mask:0xf bank_mask:0xf
  v_add_f32_dpp v13, v13, v13 row_ror:8 row_mask:0xf bank_mask:0xf
  s_nop 1
  v_add_f32_dpp v12, v12, v12 row_ror:4 row_mask:0xf bank_mask:0xf
  v_add_f32_dpp v13, v13, v13 row_ror:4 row_mask:0xf bank_mask:0xf
  s_nop 1
  v_add_f32_dpp v12, v12, v12 row_ror:2 row_mask:0xf bank_mask:0xf
  v_add_f32_dpp v13, v13, v13 row_ror:2 row_mask:0xf bank_mask:0xf
  s_nop 1
  v_add_f32_dpp v12, v12, v12 row_ror:1 row_mask:0xf bank_mask:0xf
  v_add_f32_dpp v13, v13, v13 row_ror:1 row_mask:0xf bank_mask:0xf
  s_nop 1
  v_mov_b32 v16, v12
  v_mov_b32 v17, v13
  s_nop 1
  v_permlane16_swap_b32 v16, v12
  v_permlane16_swap_b32 v17, v13
  s_nop 1
  v_add_f32 v12, v12, v16
  v_add_f32 v13, v13, v17
  v_mov_b32 v16, v12
  v_mov_b32 v17, v13
  s_nop 1
  v_permlane32_swap_b32 v16, v12
  v_permlane32_swap_b32 v17, v13
  s_nop 1
  v_add_f32 v12, v12, v16
  v_add_f32 v13, v13, v17
  s_lshl_b32 s60, s96, 2
  s_add_u32 s60, s60, 16859136
  s_mov_b64 exec, 1
  buffer_store_dwordx2 v[12:13], v29, s[12:15], s60 offen sc1
  s_mov_b64 exec, -1
  v_readfirstlane_b32 s64, v14
  s_cmp_eq_u32 s64, 1
  s_cbranch_scc1 L_DBG_OK
  s_mov_b32 s65, 524288
L_DBG_P:
  s_waitcnt vmcnt(0)
  v_readfirstlane_b32 s64, v14
  s_sub_u32 s65, s65, 1
  s_cbranch_scc1 L_DBG_OK
  s_cmp_eq_u32 s64, 1
  s_cbranch_scc1 L_DBG_OK
  s_sleep 2
  buffer_load_dword v14, v29, s[20:23], 0 offen sc1
  s_branch L_DBG_P
L_DBG_OK:
  s_lshl_b32 s60, s69, 11
  s_add_u32 s60, s60, 135168
  v_add_u32 v5, s60, v4
  s_barrier
  ds_read_b128 v[8:11], v5
  ds_read_b128 v[12:15], v5 offset:1024
  s_mov_b64 exec, s[66:67]
  ds_read_b128 v[176:179], v3 offset:0
  ds_read_b128 v[180:183], v3 offset:512
  s_mov_b64 exec, -1
  ds_read_b128 v[32:35], v2 offset:0
  s_branch L_ATTN
.p2align 6
L_COMPUTE:
  s_getpc_b64 s[96:97]
L_PFBASE:
  s_add_u32 s96, s96, L_COMPUTE - L_PFBASE
  s_addc_u32 s97, s97, -1
  s_lshl_b32 s60, s56, 13
  v_lshl_add_u32 v10, v0, 7, s60
  v_min_u32 v10, L_CODEEND - L_COMPUTE - 4, v10
  global_load_dword v170, v10, s[96:97]
  v_lshlrev_b32 v4, 4, v0
  v_and_b32 v8, 31, v0
  v_lshrrev_b32 v9, 5, v0
  s_lshl_b32 s60, s56, 6
  v_add_u32 v10, s60, v8
  v_lshlrev_b32 v10, 7, v10
  v_bfe_u32 v11, v8, 1, 3
  v_xor_b32 v11, v11, v9
  v_xor_b32 v12, 0, v11
  v_lshl_add_u32 v16, v12, 4, v10
  v_xor_b32 v12, 2, v11
  v_lshl_add_u32 v17, v12, 4, v10
  v_xor_b32 v12, 4, v11
  v_lshl_add_u32 v18, v12, 4, v10
  v_xor_b32 v12, 6, v11
  v_lshl_add_u32 v19, v12, 4, v10
  v_bfe_u32 v11, v0, 2, 2
  v_lshl_add_u32 v11, v9, 3, v11
  v_lshlrev_b32 v11, 6, v11
  v_bfe_u32 v12, v0, 4, 1
  v_lshl_add_u32 v11, v12, 5, v11
  v_and_b32 v12, 3, v0
  v_lshl_add_u32 v11, v12, 3, v11
  v_add_u32 v20, 0x8000, v11
  v_bfe_u32 v11, v8, 2, 1
  v_bfe_u32 v12, v8, 3, 1
  v_and_b32 v24, 19, v8
  v_lshl_or_b32 v24, v11, 3, v24
  v_lshl_or_b32 v24, v12, 2, v24
  v_lshlrev_b32 v24, 4, v24
  v_lshl_add_u32 v24, v9, 9, v24
  v_and_b32 v12, 15, v8
  v_lshlrev_b32 v12, 4, v12
  v_lshl_add_u32 v12, v9, 8, v12
  v_add_u32 v12, 0x400, v12
  v_lshrrev_b32 v11, 4, v8
  v_lshl_add_u32 v25, v11, 17, v12
  v_lshl_add_u32 v27, v11, 14, v12
  s_lshl_b32 s60, s56, 12
  v_add_u32 v27, s60, v27
  v_add_u32 v26, s60, v24
  s_lshl_b32 s60, s68, 14
  v_add_u32 v2, s60, v4
  v_lshrrev_b32 v5, 5, v0
  v_and_b32 v3, 15, v0
  v_lshlrev_b32 v3, 4, v3
  v_lshl_add_u32 v3, v5, 8, v3
  v_add_u32 v3, 0x400, v3
  v_add_u32 v3, s60, v3
  v_mov_b32 v7, 0xdddddddd
  v_and_b32 v5, 27, v0
  v_cmp_eq_u32 vcc, 16, v5
  v_mov_b32 v5, 0x3f803f80
  v_mov_b32 v29, 0
  v_cndmask_b32 v176, 0, v5, vcc
  v_mov_b32 v177, v176
  v_mov_b32 v178, v176
  v_mov_b32 v179, v176
  v_mov_b32 v180, v176
  v_mov_b32 v181, v176
  v_mov_b32 v182, v176
  v_mov_b32 v183, v176
  v_mov_b32 v184, v176
  v_mov_b32 v185, v176
  v_mov_b32 v186, v176
  v_mov_b32 v187, v176
  v_mov_b32 v188, v176
  v_mov_b32 v189, v176
  v_mov_b32 v190, v176
  v_mov_b32 v191, v176
  v_mov_b32 v224, 0
  v_mov_b32 v225, 0
  v_mov_b32 v226, 0
  v_mov_b32 v227, 0
  v_mov_b32 v228, 0
  v_mov_b32 v229, 0
  v_mov_b32 v230, 0
  v_mov_b32 v231, 0
  v_mov_b32 v232, 0
  v_mov_b32 v233, 0
  v_mov_b32 v234, 0
  v_mov_b32 v235, 0
  v_mov_b32 v236, 0
  v_mov_b32 v237, 0
  v_mov_b32 v238, 0
  v_mov_b32 v239, 0
  v_mov_b32 v240, 0
  v_mov_b32 v241, 0
  v_mov_b32 v242, 0
  v_mov_b32 v243, 0
  v_mov_b32 v244, 0
  v_mov_b32 v245, 0
  v_mov_b32 v246, 0
  v_mov_b32 v247, 0
  v_mov_b32 v248, 0
  v_mov_b32 v249, 0
  v_mov_b32 v250, 0
  v_mov_b32 v251, 0
  v_mov_b32 v252, 0
  v_mov_b32 v253, 0
  v_mov_b32 v254, 0
  v_mov_b32 v255, 0
  v_mov_b32 v208, 0
  v_mov_b32 v209, 0
  v_mov_b32 v210, 0
  v_mov_b32 v211, 0
  v_mov_b32 v212, 0
  v_mov_b32 v213, 0
  v_mov_b32 v214, 0
  v_mov_b32 v215, 0
  v_mov_b32 v216, 0
  v_mov_b32 v217, 0
  v_mov_b32 v218, 0
  v_mov_b32 v219, 0
  v_mov_b32 v220, 0
  v_mov_b32 v221, 0
  v_mov_b32 v222, 0
  v_mov_b32 v223, 0
  v_mov_b32 v30, 1
  v_mov_b32 v31, 0
  s_mov_b32 s66, 0x0000ffff
  s_mov_b32 s67, 0x0000ffff
  v_lshrrev_b32 v28, 3, v0
  v_lshlrev_b32 v28, 10, v28
  v_lshrrev_b32 v5, 2, v0
  v_and_b32 v5, 4, v5
  v_xor_b32 v5, v5, v0
  v_and_b32 v5, 7, v5
  v_lshl_add_u32 v28, v5, 4, v28
  v_mov_b32 v32, 0
  v_mov_b32 v33, 0
  v_mov_b32 v34, 0
  v_mov_b32 v35, 0
  v_mov_b32 v36, 0
  v_mov_b32 v37, 0
  v_mov_b32 v38, 0
  v_mov_b32 v39, 0
  v_mov_b32 v40, 0
  v_mov_b32 v41, 0
  v_mov_b32 v42, 0
  v_mov_b32 v43, 0
  v_mov_b32 v44, 0
  v_mov_b32 v45, 0
  v_mov_b32 v46, 0
  v_mov_b32 v47, 0
  v_mov_b32 v48, 0
  v_mov_b32 v49, 0
  v_mov_b32 v50, 0
  v_mov_b32 v51, 0
  v_mov_b32 v52, 0
  v_mov_b32 v53, 0
  v_mov_b32 v54, 0
  v_mov_b32 v55, 0
  v_mov_b32 v56, 0
  v_mov_b32 v57, 0
  v_mov_b32 v58, 0
  v_mov_b32 v59, 0
  v_mov_b32 v60, 0
  v_mov_b32 v61, 0
  v_mov_b32 v62, 0
  v_mov_b32 v63, 0
  v_mov_b32 v64, 0
  v_mov_b32 v65, 0
  v_mov_b32 v66, 0
  v_mov_b32 v67, 0
  v_mov_b32 v68, 0
  v_mov_b32 v69, 0
  v_mov_b32 v70, 0
  v_mov_b32 v71, 0
  v_mov_b32 v72, 0
  v_mov_b32 v73, 0
  v_mov_b32 v74, 0
  v_mov_b32 v75, 0
  v_mov_b32 v76, 0
  v_mov_b32 v77, 0
  v_mov_b32 v78, 0
  v_mov_b32 v79, 0
  v_mov_b32 v80, 0
  v_mov_b32 v81, 0
  v_mov_b32 v82, 0
  v_mov_b32 v83, 0
  v_mov_b32 v84, 0
  v_mov_b32 v85, 0
  v_mov_b32 v86, 0
  v_mov_b32 v87, 0
  v_mov_b32 v88, 0
  v_mov_b32 v89, 0
  v_mov_b32 v90, 0
  v_mov_b32 v91, 0
  v_mov_b32 v92, 0
  v_mov_b32 v93, 0
  v_mov_b32 v94, 0
  v_mov_b32 v95, 0
  v_mov_b32 v96, 0
  v_mov_b32 v97, 0
  v_mov_b32 v98, 0
  v_mov_b32 v99, 0
  v_mov_b32 v100, 0
  v_mov_b32 v101, 0
  v_mov_b32 v102, 0
  v_mov_b32 v103, 0
  v_mov_b32 v104, 0
  v_mov_b32 v105, 0
  v_mov_b32 v106, 0
  v_mov_b32 v107, 0
  v_mov_b32 v108, 0
  v_mov_b32 v109, 0
  v_mov_b32 v110, 0
  v_mov_b32 v111, 0
  v_mov_b32 v112, 0
  v_mov_b32 v113, 0
  v_mov_b32 v114, 0
  v_mov_b32 v115, 0
  v_mov_b32 v116, 0
  v_mov_b32 v117, 0
  v_mov_b32 v118, 0
  v_mov_b32 v119, 0
  v_mov_b32 v120, 0
  v_mov_b32 v121, 0
  v_mov_b32 v122, 0
  v_mov_b32 v123, 0
  v_mov_b32 v124, 0
  v_mov_b32 v125, 0
  v_mov_b32 v126, 0
  v_mov_b32 v127, 0
  s_mov_b32 s96, 0x3eb8aa3b
  s_mov_b32 s97, 0x3eb8aa3b
  s_mov_b32 s98, 4294877184
  s_mov_b32 s99, 45056
  s_waitcnt lgkmcnt(0)
  s_mov_b32 s12, s54
  s_mov_b32 s13, s55
  s_mov_b32 s14, 0x1016000
  s_mov_b32 s15, 0x20000
  s_mov_b32 s20, s52
  s_mov_b32 s21, s53
  s_mov_b32 s22, 0x100
  s_mov_b32 s23, 0x20000
  s_lshl_b32 s60, s2, 3
  s_or_b32 s101, s60, s56
  s_cbranch_scc1 L_NOCLR
  v_lshlrev_b32 v14, 8, v0
  v_mov_b32 v8, 0
  v_mov_b32 v9, 0
  v_mov_b32 v10, 0
  v_mov_b32 v11, 0
  s_mov_b32 s60, 16777216
  buffer_store_dwordx4 v[8:11], v14, s[12:15], s60 offen sc1
  s_mov_b32 s60, 16793600
  buffer_store_dwordx4 v[8:11], v14, s[12:15], s60 offen sc1
  s_mov_b32 s60, 16809984
  buffer_store_dwordx4 v[8:11], v14, s[12:15], s60 offen sc1
  s_mov_b32 s60, 16826368
  buffer_store_dwordx4 v[8:11], v14, s[12:15], s60 offen sc1
  s_mov_b32 s60, 16842752
  buffer_store_dwordx4 v[8:11], v14, s[12:15], s60 offen sc1
L_NOCLR:
  s_lshl_b32 s60, s57, 7
  s_lshl_b32 s61, s58, 3
  s_add_u32 s60, s60, s61
  s_lshl_b32 s61, s56, 1
  s_add_u32 s60, s60, s61
  s_lshl_b32 s94, s60, 11
  s_add_u32 s94, s94, 4194304
  s_add_u32 s95, s94, 0x20000
  s_barrier
  ds_read_b128 v[128:131], v16 offset:0
  ds_read_b128 v[132:135], v16 offset:4096
  ds_read_b64_tr_b16 v[148:149], v20 offset:4096
  ds_read_b64_tr_b16 v[150:151], v20 offset:4352
  ds_read_b64_tr_b16 v[152:153], v20 offset:8192
  ds_read_b64_tr_b16 v[154:155], v20 offset:8448
  ds_read_b64_tr_b16 v[144:145], v20 offset:0
  ds_read_b64_tr_b16 v[146:147], v20 offset:256
  s_mov_b32 s24, s50
  s_mov_b32 s25, s51
  s_mov_b32 s26, 0x200000
  s_mov_b32 s27, 0x20000
  s_and_b32 s60, s58, 1
  s_lshl_b32 s60, s60, 2
  s_and_b32 s61, s57, 3
  s_add_u32 s33, s60, s61
  s_cmp_eq_u32 s33, 7
  s_cselect_b32 s59, 0, s33
  s_mov_b32 s59, 0
  s_lshr_b32 s34, s57, 2
  s_and_b32 s59, s34, 1
  s_lshl_b32 s59, s59, 2
  s_lshr_b32 s60, s34, 1
  s_add_u32 s59, s59, s60
  s_lshl_b32 s60, s69, 1
  s_add_u32 s60, s60, s68
  s_lshl_b32 s49, s60, 14
  s_lshl_b32 s32, s56, 13
  s_add_u32 s32, s32, 0x8000
  s_lshl_b32 s48, s56, 12
  s_add_u32 s48, s48, 122880
  s_and_b32 s60, s57, 28
  s_lshr_b32 s62, s58, 1
  s_add_u32 s35, s60, s62
  s_lshr_b32 s61, s49, 3
  s_lshl_b32 s60, s35, 17
  s_add_u32 s61, s61, s60
  s_add_u32 s61, s61, 12582912
  s_mov_b32 s55, 0
  s_mov_b32 s60, 0
  s_cmp_ge_u32 s60, s59
  s_addc_u32 s60, s60, 0
  s_lshr_b32 s64, s60, 2
  s_lshl_b32 s60, s60, 1
  s_and_b32 s60, s60, 6
  s_add_u32 s60, s60, s64
  s_lshl_b32 s62, s60, 0
  s_or_b32 s55, s55, s62
  s_lshl_b32 s60, s60, 14
  s_add_u32 s42, s60, s61
  s_mov_b32 s60, 1
  s_cmp_ge_u32 s60, s59
  s_addc_u32 s60, s60, 0
  s_lshr_b32 s64, s60, 2
  s_lshl_b32 s60, s60, 1
  s_and_b32 s60, s60, 6
  s_add_u32 s60, s60, s64
  s_lshl_b32 s62, s60, 4
  s_or_b32 s55, s55, s62
  s_lshl_b32 s60, s60, 14
  s_add_u32 s43, s60, s61
  s_mov_b32 s60, 2
  s_cmp_ge_u32 s60, s59
  s_addc_u32 s60, s60, 0
  s_lshr_b32 s64, s60, 2
  s_lshl_b32 s60, s60, 1
  s_and_b32 s60, s60, 6
  s_add_u32 s60, s60, s64
  s_lshl_b32 s62, s60, 8
  s_or_b32 s55, s55, s62
  s_lshl_b32 s60, s60, 14
  s_add_u32 s44, s60, s61
  s_mov_b32 s60, 3
  s_cmp_ge_u32 s60, s59
  s_addc_u32 s60, s60, 0
  s_lshr_b32 s64, s60, 2
  s_lshl_b32 s60, s60, 1
  s_and_b32 s60, s60, 6
  s_add_u32 s60, s60, s64
  s_lshl_b32 s62, s60, 12
  s_or_b32 s55, s55, s62
  s_lshl_b32 s60, s60, 14
  s_add_u32 s45, s60, s61
  s_mov_b32 s60, 4
  s_cmp_ge_u32 s60, s59
  s_addc_u32 s60, s60, 0
  s_lshr_b32 s64, s60, 2
  s_lshl_b32 s60, s60, 1
  s_and_b32 s60, s60, 6
  s_add_u32 s60, s60, s64
  s_lshl_b32 s62, s60, 16
  s_or_b32 s55, s55, s62
  s_lshl_b32 s60, s60, 14
  s_add_u32 s50, s60, s61
  s_mov_b32 s60, 5
  s_cmp_ge_u32 s60, s59
  s_addc_u32 s60, s60, 0
  s_lshr_b32 s64, s60, 2
  s_lshl_b32 s60, s60, 1
  s_and_b32 s60, s60, 6
  s_add_u32 s60, s60, s64
  s_lshl_b32 s62, s60, 20
  s_or_b32 s55, s55, s62
  s_lshl_b32 s60, s60, 14
  s_add_u32 s51, s60, s61
  s_mov_b32 s60, 6
  s_cmp_ge_u32 s60, s59
  s_addc_u32 s60, s60, 0
  s_lshr_b32 s64, s60, 2
  s_lshl_b32 s60, s60, 1
  s_and_b32 s60, s60, 6
  s_add_u32 s60, s60, s64
  s_mov_b32 s38, s60
  s_lshl_b32 s60, s60, 14
  s_add_u32 s52, s60, s61
  s_mov_b32 s60, s34
  s_mov_b32 s39, s60
  s_lshl_b32 s60, s60, 14
  s_add_u32 s53, s60, s61
  s_mov_b32 s60, 0x3fb8aa3b
  s_mov_b32 s61, 0xbfb8aa3b
  s_cmp_lt_u32 s57, 16
  s_cselect_b32 s37, s61, s60
  s_lshl_b32 s36, s33, 7
  s_lshl_b32 s60, s69, 5
  s_add_u32 s36, s36, s60
  s_lshl_b32 s60, s58, 2
  s_lshr_b32 s61, s57, 3
  s_add_u32 s61, s61, s60
  s_lshl_b32 s61, s61, 8
  s_add_u32 s54, s61, 16842752
  s_add_u32 s60, s60, s69
  s_lshl_b32 s60, s60, 8
  s_add_u32 s0, s60, 16859136
  s_lshr_b32 s60, s35, 2
  s_lshl_b32 s60, s60, 10
  s_add_u32 s1, s60, 16842752
  s_mov_b32 s30, 0x80000
  s_mov_b32 s31, 0x20000
  v_bfe_u32 v6, v0, 2, 2
  v_lshrrev_b32 v1, 5, v0
  v_lshl_add_u32 v6, v1, 2, v6
  v_bfe_u32 v5, v0, 4, 1
  v_and_b32 v1, 1, v0
  v_lshl_or_b32 v5, v5, 1, v1
  v_bfe_u32 v1, v0, 3, 1
  v_lshl_or_b32 v5, v1, 2, v5
  s_lshl_b32 s60, s69, 1
  v_xor_b32 v5, s60, v5
  v_lshlrev_b32 v5, 4, v5
  v_lshl_add_u32 v6, v6, 7, v5
  v_bfe_u32 v1, v0, 1, 1
  v_lshl_add_u32 v6, v1, 3, v6
  v_add_u32 v6, s32, v6
  s_lshl_b32 s60, s33, 7
  v_add_u32 v28, s60, v28
  s_cmp_lg_u32 s101, 0
  s_cbranch_scc1 L_NOPUB
  s_waitcnt vmcnt(0)
  s_mov_b64 exec, 1
  buffer_store_dword v30, v29, s[20:23], 0 offen sc1
  s_mov_b64 exec, -1
L_NOPUB:
  s_mov_b32 s62, 0
  s_mov_b32 s63, 7
.p2align 3
L_GLOOP:
  s_waitcnt lgkmcnt(0)
  s_cmp_eq_u32 s62, 2
  s_cselect_b32 s64, s98, s99
  s_cselect_b32 s62, -1, s62
  s_add_u32 s62, s62, 1
  s_sub_u32 s63, s63, 1
  s_cmp_lg_u32 s63, 0
  v_mfma_f32_32x32x16_bf16 v[64:79], v[148:151], v[128:131], v[64:79]
  ds_read_b128 v[136:139], v17 offset:0
  ds_read_b128 v[140:143], v17 offset:4096
  ds_read_b64_tr_b16 v[160:161], v20 offset:5120
  v_mfma_f32_32x32x16_bf16 v[80:95], v[148:151], v[132:135], v[80:95]
  ds_read_b64_tr_b16 v[162:163], v20 offset:5376
  ds_read_b64_tr_b16 v[164:165], v20 offset:9216
  ds_read_b64_tr_b16 v[166:167], v20 offset:9472
  v_mfma_f32_32x32x16_bf16 v[96:111], v[128:131], v[152:155], v[96:111]
  ds_read_b64_tr_b16 v[156:157], v20 offset:1024
  ds_read_b64_tr_b16 v[158:159], v20 offset:1280
  v_mfma_f32_32x32x16_bf16 v[112:127], v[132:135], v[152:155], v[112:127]
  v_mfma_f32_32x32x16_bf16 v[32:47], v[144:147], v[128:131], v[32:47]
  v_mfma_f32_32x32x16_bf16 v[48:63], v[144:147], v[132:135], v[48:63]
  s_waitcnt lgkmcnt(0)
  v_mfma_f32_32x32x16_bf16 v[64:79], v[160:163], v[136:139], v[64:79]
  ds_read_b128 v[128:131], v18 offset:0
  ds_read_b128 v[132:135], v18 offset:4096
  ds_read_b64_tr_b16 v[148:149], v20 offset:6144
  v_mfma_f32_32x32x16_bf16 v[80:95], v[160:163], v[140:143], v[80:95]
  ds_read_b64_tr_b16 v[150:151], v20 offset:6400
  ds_read_b64_tr_b16 v[152:153], v20 offset:10240
  ds_read_b64_tr_b16 v[154:155], v20 offset:10496
  v_mfma_f32_32x32x16_bf16 v[96:111], v[136:139], v[164:167], v[96:111]
  ds_read_b64_tr_b16 v[144:145], v20 offset:2048
  ds_read_b64_tr_b16 v[146:147], v20 offset:2304
  v_mfma_f32_32x32x16_bf16 v[112:127], v[140:143], v[164:167], v[112:127]
  v_mfma_f32_32x32x16_bf16 v[32:47], v[156:159], v[136:139], v[32:47]
  v_mfma_f32_32x32x16_bf16 v[48:63], v[156:159], v[140:143], v[48:63]
  s_waitcnt lgkmcnt(0)
  v_mfma_f32_32x32x16_bf16 v[64:79], v[148:151], v[128:131], v[64:79]
  ds_read_b128 v[136:139], v19 offset:0
  ds_read_b128 v[140:143], v19 offset:4096
  ds_read_b64_tr_b16 v[160:161], v20 offset:7168
  v_mfma_f32_32x32x16_bf16 v[80:95], v[148:151], v[132:135], v[80:95]
  ds_read_b64_tr_b16 v[162:163], v20 offset:7424
  ds_read_b64_tr_b16 v[164:165], v20 offset:11264
  ds_read_b64_tr_b16 v[166:167], v20 offset:11520
  v_mfma_f32_32x32x16_bf16 v[96:111], v[128:131], v[152:155], v[96:111]
  ds_read_b64_tr_b16 v[156:157], v20 offset:3072
  ds_read_b64_tr_b16 v[158:159], v20 offset:3328
  v_mfma_f32_32x32x16_bf16 v[112:127], v[132:135], v[152:155], v[112:127]
  v_mfma_f32_32x32x16_bf16 v[32:47], v[144:147], v[128:131], v[32:47]
  v_mfma_f32_32x32x16_bf16 v[48:63], v[144:147], v[132:135], v[48:63]
  s_waitcnt lgkmcnt(0)
  s_barrier
  v_add_u32 v16, s64, v16
  v_add_u32 v20, s64, v20
  v_mfma_f32_32x32x16_bf16 v[64:79], v[160:163], v[136:139], v[64:79]
  ds_read_b128 v[128:131], v16 offset:0
  ds_read_b128 v[132:135], v16 offset:4096
  ds_read_b64_tr_b16 v[148:149], v20 offset:4096
  v_mfma_f32_32x32x16_bf16 v[80:95], v[160:163], v[140:143], v[80:95]
  ds_read_b64_tr_b16 v[150:151], v20 offset:4352
  ds_read_b64_tr_b16 v[152:153], v20 offset:8192
  ds_read_b64_tr_b16 v[154:155], v20 offset:8448
  v_mfma_f32_32x32x16_bf16 v[96:111], v[136:139], v[164:167], v[96:111]
  ds_read_b64_tr_b16 v[144:145], v20 offset:0
  ds_read_b64_tr_b16 v[146:147], v20 offset:256
  v_mfma_f32_32x32x16_bf16 v[112:127], v[140:143], v[164:167], v[112:127]
  v_mfma_f32_32x32x16_bf16 v[32:47], v[156:159], v[136:139], v[32:47]
  v_mfma_f32_32x32x16_bf16 v[48:63], v[156:159], v[140:143], v[48:63]
  v_add_u32 v17, s64, v17
  v_add_u32 v18, s64, v18
  v_add_u32 v19, s64, v19
  s_cbranch_scc1 L_GLOOP
  s_lshl_b32 s60, s56, 11
  s_add_u32 s60, s60, 135168
  v_add_u32 v1, s60, v4
  s_waitcnt vmcnt(0) lgkmcnt(0)
  ds_read_b128 v[136:139], v17
  ds_read_b64_tr_b16 v[160:161], v20 offset:5120
  ds_read_b64_tr_b16 v[162:163], v20 offset:5376
  ds_read_b64_tr_b16 v[164:165], v20 offset:9216
  ds_read_b64_tr_b16 v[166:167], v20 offset:9472
  ds_read_b64_tr_b16 v[156:157], v20 offset:1024
  ds_read_b64_tr_b16 v[158:159], v20 offset:1280
  v_mfma_f32_32x32x16_bf16 v[64:79], v[148:151], v[128:131], v[64:79]
  ds_read_b128 v[132:135], v18
  ds_read_b64_tr_b16 v[196:197], v20 offset:6144
  ds_read_b64_tr_b16 v[198:199], v20 offset:6400
  ds_read_b64_tr_b16 v[200:201], v20 offset:10240
  v_mfma_f32_32x32x16_bf16 v[96:111], v[128:131], v[152:155], v[96:111]
  ds_read_b64_tr_b16 v[202:203], v20 offset:10496
  ds_read_b64_tr_b16 v[192:193], v20 offset:2048
  ds_read_b64_tr_b16 v[194:195], v20 offset:2304
  v_mfma_f32_32x32x16_bf16 v[32:47], v[144:147], v[128:131], v[32:47]
  s_waitcnt lgkmcnt(7)
  s_barrier
  v_mfma_f32_32x32x16_bf16 v[64:79], v[160:163], v[136:139], v[64:79]
  ds_read_b128 v[140:143], v19
  ds_read_b64_tr_b16 v[168:169], v20 offset:7168
  ds_read_b64_tr_b16 v[170:171], v20 offset:7424
  ds_read_b64_tr_b16 v[172:173], v20 offset:11264
  v_mfma_f32_32x32x16_bf16 v[96:111], v[136:139], v[164:167], v[96:111]
  ds_read_b64_tr_b16 v[174:175], v20 offset:11520
  ds_read_b64_tr_b16 v[204:205], v20 offset:3072
  ds_read_b64_tr_b16 v[206:207], v20 offset:3328
  ds_read_b128 v[128:131], v16 offset:4096
  v_mfma_f32_32x32x16_bf16 v[32:47], v[156:159], v[136:139], v[32:47]
  s_waitcnt lgkmcnt(8)
  v_mfma_f32_32x32x16_bf16 v[64:79], v[196:199], v[132:135], v[64:79]
  ds_read_b128 v[136:139], v17 offset:4096
  v_mfma_f32_32x32x16_bf16 v[96:111], v[132:135], v[200:203], v[96:111]
  v_mfma_f32_32x32x16_bf16 v[32:47], v[192:195], v[132:135], v[32:47]
  s_waitcnt lgkmcnt(2)
  v_mfma_f32_32x32x16_bf16 v[64:79], v[168:171], v[140:143], v[64:79]
  ds_read_b128 v[132:135], v18 offset:4096
  v_mfma_f32_32x32x16_bf16 v[96:111], v[140:143], v[172:175], v[96:111]
  v_mfma_f32_32x32x16_bf16 v[32:47], v[204:207], v[140:143], v[32:47]
  s_waitcnt lgkmcnt(1)
  v_mfma_f32_32x32x16_bf16 v[80:95], v[148:151], v[128:131], v[80:95]
  ds_read_b128 v[140:143], v19 offset:4096
  s_waitcnt lgkmcnt(1)
  v_mfma_f32_32x32x16_bf16 v[80:95], v[160:163], v[136:139], v[80:95]
  v_mfma_f32_32x32x16_bf16 v[80:95], v[196:199], v[132:135], v[80:95]
  s_nop 2
  v_cvt_pk_bf16_f32 v64, v64, v65
  v_cvt_pk_bf16_f32 v65, v66, v67
  v_cvt_pk_bf16_f32 v66, v68, v69
  v_cvt_pk_bf16_f32 v67, v70, v71
  v_cvt_pk_bf16_f32 v68, v72, v73
  s_waitcnt lgkmcnt(0)
  v_mfma_f32_32x32x16_bf16 v[80:95], v[168:171], v[140:143], v[80:95]
  v_cvt_pk_bf16_f32 v69, v74, v75
  v_cvt_pk_bf16_f32 v70, v76, v77
  v_cvt_pk_bf16_f32 v71, v78, v79
  ds_write_b128 v26, v[64:67] offset:0
  ds_write_b128 v26, v[68:71] offset:16384
  v_mfma_f32_32x32x16_bf16 v[112:127], v[128:131], v[152:155], v[112:127]
  v_cvt_pk_bf16_f32 v96, v96, v97
  v_cvt_pk_bf16_f32 v97, v98, v99
  v_cvt_pk_bf16_f32 v98, v100, v101
  v_cvt_pk_bf16_f32 v99, v102, v103
  v_cvt_pk_bf16_f32 v100, v104, v105
  v_cvt_pk_bf16_f32 v101, v106, v107
  v_mfma_f32_32x32x16_bf16 v[112:127], v[136:139], v[164:167], v[112:127]
  v_cvt_pk_bf16_f32 v102, v108, v109
  v_cvt_pk_bf16_f32 v103, v110, v111
  ds_write_b128 v27, v[96:99] offset:0
  ds_write_b128 v27, v[100:103] offset:512
  v_pk_mul_f32 v[40:41], v[40:41], s[96:97]
  v_mfma_f32_32x32x16_bf16 v[112:127], v[132:135], v[200:203], v[112:127]
  v_pk_mul_f32 v[42:43], v[42:43], s[96:97]
  v_pk_mul_f32 v[44:45], v[44:45], s[96:97]
  v_pk_mul_f32 v[46:47], v[46:47], s[96:97]
  v_cvt_pk_bf16_f32 v40, v40, v41
  v_cvt_pk_bf16_f32 v41, v42, v43
  v_cvt_pk_bf16_f32 v42, v44, v45
  v_mfma_f32_32x32x16_bf16 v[112:127], v[140:143], v[172:175], v[112:127]
  v_cvt_pk_bf16_f32 v43, v46, v47
  ds_write_b128 v1, v[40:43] offset:0
  v_pk_mul_f32 v[32:33], v[32:33], s[96:97]
  v_pk_mul_f32 v[34:35], v[34:35], s[96:97]
  v_pk_mul_f32 v[36:37], v[36:37], s[96:97]
  v_pk_mul_f32 v[38:39], v[38:39], s[96:97]
  v_mfma_f32_32x32x16_bf16 v[48:63], v[144:147], v[128:131], v[48:63]
  v_cvt_pk_bf16_f32 v8, v32, v33
  v_cvt_pk_bf16_f32 v9, v34, v35
  v_cvt_pk_bf16_f32 v10, v36, v37
  v_cvt_pk_bf16_f32 v11, v38, v39
  v_cvt_pk_bf16_f32 v80, v80, v81
  v_cvt_pk_bf16_f32 v81, v82, v83
  v_mfma_f32_32x32x16_bf16 v[48:63], v[156:159], v[136:139], v[48:63]
  v_cvt_pk_bf16_f32 v82, v84, v85
  v_cvt_pk_bf16_f32 v83, v86, v87
  v_cvt_pk_bf16_f32 v84, v88, v89
  v_cvt_pk_bf16_f32 v85, v90, v91
  v_cvt_pk_bf16_f32 v86, v92, v93
  v_cvt_pk_bf16_f32 v87, v94, v95
  v_mfma_f32_32x32x16_bf16 v[48:63], v[192:195], v[132:135], v[48:63]
  ds_write_b128 v26, v[80:83] offset:2048
  ds_write_b128 v26, v[84:87] offset:18432
  s_nop 1
  v_mfma_f32_32x32x16_bf16 v[48:63], v[204:207], v[140:143], v[48:63]
  v_cvt_pk_bf16_f32 v112, v112, v113
  v_cvt_pk_bf16_f32 v113, v114, v115
  v_cvt_pk_bf16_f32 v114, v116, v117
  v_cvt_pk_bf16_f32 v115, v118, v119
  v_cvt_pk_bf16_f32 v116, v120, v121
  v_cvt_pk_bf16_f32 v117, v122, v123
  v_cvt_pk_bf16_f32 v118, v124, v125
  v_cvt_pk_bf16_f32 v119, v126, v127
  ds_write_b128 v27, v[112:115] offset:2048
  ds_write_b128 v27, v[116:119] offset:2560
  s_nop 1
  v_pk_mul_f32 v[56:57], v[56:57], s[96:97]
  v_pk_mul_f32 v[58:59], v[58:59], s[96:97]
  v_pk_mul_f32 v[60:61], v[60:61], s[96:97]
  v_pk_mul_f32 v[62:63], v[62:63], s[96:97]
  v_cvt_pk_bf16_f32 v56, v56, v57
  v_cvt_pk_bf16_f32 v57, v58, v59
  v_cvt_pk_bf16_f32 v58, v60, v61
  v_cvt_pk_bf16_f32 v59, v62, v63
  ds_write_b128 v1, v[56:59] offset:1024
  v_pk_mul_f32 v[48:49], v[48:49], s[96:97]
  v_pk_mul_f32 v[50:51], v[50:51], s[96:97]
  v_pk_mul_f32 v[52:53], v[52:53], s[96:97]
  v_pk_mul_f32 v[54:55], v[54:55], s[96:97]
  v_cvt_pk_bf16_f32 v12, v48, v49
  v_cvt_pk_bf16_f32 v13, v50, v51
  v_cvt_pk_bf16_f32 v14, v52, v53
  v_cvt_pk_bf16_f32 v15, v54, v55
  s_waitcnt lgkmcnt(0)
  s_barrier
  s_mov_b64 exec, s[66:67]
  ds_read_b128 v[176:179], v3 offset:0
  ds_read_b128 v[180:183], v3 offset:512
  s_mov_b64 exec, -1
  ds_read_b128 v[32:35], v2 offset:0
  buffer_store_dwordx4 v[64:67], v24, s[12:15], s94 offen offset:0 sc1
  buffer_store_dwordx4 v[68:71], v24, s[12:15], s95 offen offset:0 sc1
  buffer_store_dwordx4 v[96:99], v25, s[12:15], s94 offen offset:0 sc1
  buffer_store_dwordx4 v[100:103], v25, s[12:15], s94 offen offset:512 sc1
  buffer_store_dwordx4 v[80:83], v24, s[12:15], s94 offen offset:2048 sc1
  buffer_store_dwordx4 v[84:87], v24, s[12:15], s95 offen offset:2048 sc1
  buffer_store_dwordx4 v[112:115], v25, s[12:15], s94 offen offset:2048 sc1
  buffer_store_dwordx4 v[116:119], v25, s[12:15], s94 offen offset:2560 sc1
L_ATTN:
  s_lshl_b32 s60, s57, 1
  s_add_u32 s60, s60, s68
  s_lshl_b32 s100, s60, 17
  s_add_u32 s100, s100, 4194304
  s_lshl_b32 s61, s69, 12
  s_add_u32 s94, s100, s61
  s_lshl_b32 s95, s68, 14
  s_add_u32 s95, s95, s61
  s_lshl_b32 s61, s58, 2
  s_add_u32 s61, s61, s69
  s_lshl_b32 s61, s61, 6
  s_add_u32 s60, s60, s61
  s_lshl_b32 s98, s60, 11
  s_add_u32 s98, s98, 12582912
  s_waitcnt lgkmcnt(0)
  v_mfma_f32_32x32x16_bf16 v[192:207], v[32:35], v[8:11], 0
  s_add_u32 s96, s58, 1
  s_and_b32 s96, s96, 7
  s_mov_b32 s99, 0
  s_nop 8
  v_exp_f32 v192, v192
  v_exp_f32 v193, v193
  v_smfmac_f32_32x32x32_bf16 v[240:255], v[188:191], v[216:223], v7
  s_setprio 3
  s_mov_b64 exec, s[66:67]
  ds_read_b128 v[184:187], v3 offset:2048
  ds_read_b128 v[188:191], v3 offset:2560
  s_mov_b64 exec, -1
  ds_read_b128 v[36:39], v2 offset:2048
  v_exp_f32 v194, v194
  v_exp_f32 v195, v195
  v_exp_f32 v196, v196
  v_mfma_f32_32x32x16_bf16 v[208:223], v[32:35], v[12:15], 0
  v_exp_f32 v197, v197
  v_exp_f32 v198, v198
  v_exp_f32 v199, v199
  v_exp_f32 v200, v200
  v_exp_f32 v201, v201
  v_smfmac_f32_32x32x32_bf16 v[224:239], v[176:179], v[192:199], v7
  v_exp_f32 v202, v202
  v_exp_f32 v203, v203
  v_exp_f32 v204, v204
  v_exp_f32 v205, v205
  v_exp_f32 v206, v206
  v_exp_f32 v207, v207
  v_exp_f32 v208, v208
  v_exp_f32 v209, v209
  v_smfmac_f32_32x32x32_bf16 v[224:239], v[180:183], v[200:207], v7
  v_exp_f32 v210, v210
  v_exp_f32 v211, v211
  v_exp_f32 v212, v212
  s_waitcnt lgkmcnt(0)
  v_mfma_f32_32x32x16_bf16 v[192:207], v[36:39], v[8:11], 0
  v_exp_f32 v213, v213
  v_exp_f32 v214, v214
  v_exp_f32 v215, v215
  v_exp_f32 v216, v216
  v_exp_f32 v217, v217
  v_smfmac_f32_32x32x32_bf16 v[240:255], v[176:179], v[208:215], v7
  s_cmp_eq_u32 s68, 0
  v_exp_f32 v218, v218
  v_exp_f32 v219, v219
  v_exp_f32 v220, v220
  v_exp_f32 v221, v221
  v_exp_f32 v222, v222
  v_exp_f32 v223, v223
  v_exp_f32 v192, v192
  v_exp_f32 v193, v193
  v_smfmac_f32_32x32x32_bf16 v[240:255], v[180:183], v[216:223], v7
  s_cbranch_scc0 L_SIG_R
  s_lshl_b32 s60, s57, 3
  s_add_u32 s60, s60, s58
  s_lshl_b32 s60, s60, 8
  s_lshl_b32 s61, s69, 2
  s_add_u32 s60, s60, s61
  s_add_u32 s60, s60, 16777216
  s_waitcnt vmcnt(0)
  s_mov_b64 exec, 1
  buffer_store_dword v30, v29, s[12:15], s60 offen sc1
  s_mov_b64 exec, -1
L_SIG_R:
  s_mov_b64 exec, s[66:67]
  ds_read_b128 v[176:179], v3 offset:4096
  ds_read_b128 v[180:183], v3 offset:4608
  s_mov_b64 exec, -1
  ds_read_b128 v[32:35], v2 offset:4096
  v_exp_f32 v194, v194
  v_exp_f32 v195, v195
  v_exp_f32 v196, v196
  v_mfma_f32_32x32x16_bf16 v[208:223], v[36:39], v[12:15], 0
  v_exp_f32 v197, v197
  v_exp_f32 v198, v198
  v_exp_f32 v199, v199
  v_exp_f32 v200, v200
  v_exp_f32 v201, v201
  v_smfmac_f32_32x32x32_bf16 v[224:239], v[184:187], v[192:199], v7
  v_exp_f32 v202, v202
  v_exp_f32 v203, v203
  v_exp_f32 v204, v204
  v_exp_f32 v205, v205
  v_exp_f32 v206, v206
  v_exp_f32 v207, v207
  v_exp_f32 v208, v208
  v_exp_f32 v209, v209
  v_smfmac_f32_32x32x32_bf16 v[224:239], v[188:191], v[200:207], v7
  v_exp_f32 v210, v210
  v_exp_f32 v211, v211
  v_exp_f32 v212, v212
  s_waitcnt lgkmcnt(0)
  v_mfma_f32_32x32x16_bf16 v[192:207], v[32:35], v[8:11], 0
  v_exp_f32 v213, v213
  v_exp_f32 v214, v214
  v_exp_f32 v215, v215
  v_exp_f32 v216, v216
  v_exp_f32 v217, v217
  v_smfmac_f32_32x32x32_bf16 v[240:255], v[184:187], v[208:215], v7
  v_exp_f32 v218, v218
  v_exp_f32 v219, v219
  v_exp_f32 v220, v220
  v_exp_f32 v221, v221
  v_exp_f32 v222, v222
  v_exp_f32 v223, v223
  v_exp_f32 v192, v192
  v_exp_f32 v193, v193
  v_smfmac_f32_32x32x32_bf16 v[240:255], v[188:191], v[216:223], v7
  s_setprio 2
  s_mov_b64 exec, s[66:67]
  ds_read_b128 v[184:187], v3 offset:6144
  ds_read_b128 v[188:191], v3 offset:6656
  s_mov_b64 exec, -1
  ds_read_b128 v[36:39], v2 offset:6144
  v_exp_f32 v194, v194
  v_exp_f32 v195, v195
  v_exp_f32 v196, v196
  v_mfma_f32_32x32x16_bf16 v[208:223], v[32:35], v[12:15], 0
  v_exp_f32 v197, v197
  v_exp_f32 v198, v198
  v_exp_f32 v199, v199
  v_exp_f32 v200, v200
  v_exp_f32 v201, v201
  v_smfmac_f32_32x32x32_bf16 v[224:239], v[176:179], v[192:199], v7
  v_exp_f32 v202, v202
  v_exp_f32 v203, v203
  v_exp_f32 v204, v204
  v_exp_f32 v205, v205
  v_exp_f32 v206, v206
  v_exp_f32 v207, v207
  v_exp_f32 v208, v208
  v_exp_f32 v209, v209
  v_smfmac_f32_32x32x32_bf16 v[224:239], v[180:183], v[200:207], v7
  v_exp_f32 v210, v210
  v_exp_f32 v211, v211
  v_exp_f32 v212, v212
  s_waitcnt lgkmcnt(0)
  v_mfma_f32_32x32x16_bf16 v[192:207], v[36:39], v[8:11], 0
  v_exp_f32 v213, v213
  v_exp_f32 v214, v214
  v_exp_f32 v215, v215
  v_exp_f32 v216, v216
  v_exp_f32 v217, v217
  v_smfmac_f32_32x32x32_bf16 v[240:255], v[176:179], v[208:215], v7
  v_exp_f32 v218, v218
  v_exp_f32 v219, v219
  v_exp_f32 v220, v220
  v_exp_f32 v221, v221
  v_exp_f32 v222, v222
  v_exp_f32 v223, v223
  v_exp_f32 v192, v192
  v_exp_f32 v193, v193
  v_smfmac_f32_32x32x32_bf16 v[240:255], v[180:183], v[216:223], v7
  s_mov_b64 exec, s[66:67]
  ds_read_b128 v[176:179], v3 offset:8192
  ds_read_b128 v[180:183], v3 offset:8704
  s_mov_b64 exec, -1
  ds_read_b128 v[32:35], v2 offset:8192
  v_exp_f32 v194, v194
  v_exp_f32 v195, v195
  v_exp_f32 v196, v196
  v_mfma_f32_32x32x16_bf16 v[208:223], v[36:39], v[12:15], 0
  v_exp_f32 v197, v197
  v_exp_f32 v198, v198
  v_exp_f32 v199, v199
  v_exp_f32 v200, v200
  v_exp_f32 v201, v201
  v_smfmac_f32_32x32x32_bf16 v[224:239], v[184:187], v[192:199], v7
  s_cmp_eq_u32 s68, 1
  v_exp_f32 v202, v202
  v_exp_f32 v203, v203
  v_exp_f32 v204, v204
  v_exp_f32 v205, v205
  v_exp_f32 v206, v206
  v_exp_f32 v207, v207
  v_exp_f32 v208, v208
  v_exp_f32 v209, v209
  v_smfmac_f32_32x32x32_bf16 v[224:239], v[188:191], v[200:207], v7
  s_cbranch_scc0 L_PL0_R
  s_lshl_b32 s60, s57, 3
  s_add_u32 s60, s60, s96
  s_lshl_b32 s60, s60, 8
  s_add_u32 s60, s60, 16777216
  v_and_b32 v31, 3, v0
  v_lshlrev_b32 v31, 2, v31
  buffer_load_dword v5, v31, s[12:15], s60 offen sc1
L_PL0_R:
  v_exp_f32 v210, v210
  v_exp_f32 v211, v211
  v_exp_f32 v212, v212
  s_waitcnt lgkmcnt(0)
  v_mfma_f32_32x32x16_bf16 v[192:207], v[32:35], v[8:11], 0
  v_exp_f32 v213, v213
  v_exp_f32 v214, v214
  v_exp_f32 v215, v215
  v_exp_f32 v216, v216
  v_exp_f32 v217, v217
  v_smfmac_f32_32x32x32_bf16 v[240:255], v[184:187], v[208:215], v7
  s_cmp_eq_u32 s68, 1
  v_exp_f32 v218, v218
  v_exp_f32 v219, v219
  v_exp_f32 v220, v220
  v_exp_f32 v221, v221
  v_exp_f32 v222, v222
  v_exp_f32 v223, v223
  v_exp_f32 v192, v192
  v_exp_f32 v193, v193
  v_smfmac_f32_32x32x32_bf16 v[240:255], v[188:191], v[216:223], v7
  s_cbranch_scc0 L_PL1_R
  s_mov_b32 s65, 524288
L_CC_P:
  s_waitcnt vmcnt(0)
  v_cmp_gt_u32 vcc, 1, v5
  s_sub_u32 s65, s65, 1
  s_cbranch_scc1 L_CC_OK
  s_and_b64 vcc, vcc, exec
  s_cbranch_scc0 L_CC_OK
  s_sleep 2
  buffer_load_dword v5, v31, s[12:15], s60 offen sc1
  s_branch L_CC_P
L_CC_OK:
  s_lshl_b32 s60, s57, 1
  s_lshr_b32 s61, s69, 1
  s_add_u32 s60, s60, s61
  s_lshl_b32 s60, s60, 17
  s_lshl_b32 s61, s96, 14
  s_add_u32 s60, s60, s61
  s_and_b32 s61, s69, 1
  s_lshl_b32 s61, s61, 13
  s_add_u32 s60, s60, s61
  s_add_u32 s60, s60, 4194304
  s_lshl_b32 s61, s69, 13
  s_add_u32 m0, s61, 98304
  s_add_u32 s62, s60, 4096
  buffer_load_dwordx4 v4, s[12:15], s60 offen offset:0 sc1 lds
  buffer_load_dwordx4 v4, s[12:15], s60 offen offset:1024 sc1 lds
  buffer_load_dwordx4 v4, s[12:15], s60 offen offset:2048 sc1 lds
  buffer_load_dwordx4 v4, s[12:15], s60 offen offset:3072 sc1 lds
  s_add_u32 m0, s61, 102400
  s_nop 0
  buffer_load_dwordx4 v4, s[12:15], s62 offen offset:0 sc1 lds
  buffer_load_dwordx4 v4, s[12:15], s62 offen offset:1024 sc1 lds
  buffer_load_dwordx4 v4, s[12:15], s62 offen offset:2048 sc1 lds
  buffer_load_dwordx4 v4, s[12:15], s62 offen offset:3072 sc1 lds
L_PL1_R:
  s_setprio 1
  s_mov_b64 exec, s[66:67]
  ds_read_b128 v[184:187], v3 offset:10240
  ds_read_b128 v[188:191], v3 offset:10752
  s_mov_b64 exec, -1
  ds_read_b128 v[36:39], v2 offset:10240
  v_exp_f32 v194, v194
  v_exp_f32 v195, v195
  v_exp_f32 v196, v196
  v_mfma_f32_32x32x16_bf16 v[208:223], v[32:35], v[12:15], 0
  v_exp_f32 v197, v197
  v_exp_f32 v198, v198
  v_exp_f32 v199, v199
  v_exp_f32 v200, v200
  v_exp_f32 v201, v201
  v_smfmac_f32_32x32x32_bf16 v[224:239], v[176:179], v[192:199], v7
  v_exp_f32 v202, v202
  v_exp_f32 v203, v203
  v_exp_f32 v204, v204
  v_exp_f32 v205, v205
  v_exp_f32 v206, v206
  v_exp_f32 v207, v207
  v_exp_f32 v208, v208
  v_exp_f32 v209, v209
  v_smfmac_f32_32x32x32_bf16 v[224:239], v[180:183], v[200:207], v7
  v_exp_f32 v210, v210
  v_exp_f32 v211, v211
  v_exp_f32 v212, v212
  s_waitcnt lgkmcnt(0)
  v_mfma_f32_32x32x16_bf16 v[192:207], v[36:39], v[8:11], 0
  v_exp_f32 v213, v213
  v_exp_f32 v214, v214
  v_exp_f32 v215, v215
  v_exp_f32 v216, v216
  v_exp_f32 v217, v217
  v_smfmac_f32_32x32x32_bf16 v[240:255], v[176:179], v[208:215], v7
  v_exp_f32 v218, v218
  v_exp_f32 v219, v219
  v_exp_f32 v220, v220
  v_exp_f32 v221, v221
  v_exp_f32 v222, v222
  v_exp_f32 v223, v223
  v_exp_f32 v192, v192
  v_exp_f32 v193, v193
  v_smfmac_f32_32x32x32_bf16 v[240:255], v[180:183], v[216:223], v7
  s_mov_b64 exec, s[66:67]
  ds_read_b128 v[176:179], v3 offset:12288
  ds_read_b128 v[180:183], v3 offset:12800
  s_mov_b64 exec, -1
  ds_read_b128 v[32:35], v2 offset:12288
  v_exp_f32 v194, v194
  v_exp_f32 v195, v195
  v_exp_f32 v196, v196
  v_mfma_f32_32x32x16_bf16 v[208:223], v[36:39], v[12:15], 0
  v_exp_f32 v197, v197
  v_exp_f32 v198, v198
  v_exp_f32 v199, v199
  v_exp_f32 v200, v200
  v_exp_f32 v201, v201
  v_smfmac_f32_32x32x32_bf16 v[224:239], v[184:187], v[192:199], v7
  s_cmp_eq_u32 s56, 4
  v_exp_f32 v202, v202
  v_exp_f32 v203, v203
  v_exp_f32 v204, v204
  v_exp_f32 v205, v205
  v_exp_f32 v206, v206
  v_exp_f32 v207, v207
  v_exp_f32 v208, v208
  v_exp_f32 v209, v209
  v_smfmac_f32_32x32x32_bf16 v[224:239], v[188:191], v[200:207], v7
  s_cbranch_scc0 L_NX0_R
  s_add_u32 s60, s96, 1
  s_and_b32 s60, s60, 7
  s_lshl_b32 s61, s57, 3
  s_add_u32 s60, s60, s61
  s_lshl_b32 s60, s60, 8
  s_add_u32 s60, s60, 16777216
  buffer_load_dword v5, v31, s[12:15], s60 offen sc1
L_NX0_R:
  v_exp_f32 v210, v210
  v_exp_f32 v211, v211
  v_exp_f32 v212, v212
  s_waitcnt lgkmcnt(0)
  v_mfma_f32_32x32x16_bf16 v[192:207], v[32:35], v[8:11], 0
  v_exp_f32 v213, v213
  v_exp_f32 v214, v214
  v_exp_f32 v215, v215
  v_exp_f32 v216, v216
  v_exp_f32 v217, v217
  v_smfmac_f32_32x32x32_bf16 v[240:255], v[184:187], v[208:215], v7
  v_exp_f32 v218, v218
  v_exp_f32 v219, v219
  v_exp_f32 v220, v220
  v_exp_f32 v221, v221
  v_exp_f32 v222, v222
  v_exp_f32 v223, v223
  v_exp_f32 v192, v192
  v_exp_f32 v193, v193
  v_smfmac_f32_32x32x32_bf16 v[240:255], v[188:191], v[216:223], v7
  s_setprio 0
  s_mov_b64 exec, s[66:67]
  ds_read_b128 v[184:187], v3 offset:14336
  ds_read_b128 v[188:191], v3 offset:14848
  s_mov_b64 exec, -1
  ds_read_b128 v[36:39], v2 offset:14336
  v_exp_f32 v194, v194
  v_exp_f32 v195, v195
  v_exp_f32 v196, v196
  v_mfma_f32_32x32x16_bf16 v[208:223], v[32:35], v[12:15], 0
  v_exp_f32 v197, v197
  v_exp_f32 v198, v198
  v_exp_f32 v199, v199
  v_exp_f32 v200, v200
  v_exp_f32 v201, v201
  v_smfmac_f32_32x32x32_bf16 v[224:239], v[176:179], v[192:199], v7
  v_exp_f32 v202, v202
  v_exp_f32 v203, v203
  v_exp_f32 v204, v204
  v_exp_f32 v205, v205
  v_exp_f32 v206, v206
  v_exp_f32 v207, v207
  v_exp_f32 v208, v208
  v_exp_f32 v209, v209
  v_smfmac_f32_32x32x32_bf16 v[224:239], v[180:183], v[200:207], v7
  v_exp_f32 v210, v210
  v_exp_f32 v211, v211
  v_exp_f32 v212, v212
  s_waitcnt lgkmcnt(0)
  v_mfma_f32_32x32x16_bf16 v[192:207], v[36:39], v[8:11], 0
  v_exp_f32 v213, v213
  v_exp_f32 v214, v214
  v_exp_f32 v215, v215
  v_exp_f32 v216, v216
  v_exp_f32 v217, v217
  v_smfmac_f32_32x32x32_bf16 v[240:255], v[176:179], v[208:215], v7
  s_cmp_eq_u32 s56, 4
  v_exp_f32 v218, v218
  v_exp_f32 v219, v219
  v_exp_f32 v220, v220
  v_exp_f32 v221, v221
  v_exp_f32 v222, v222
  v_exp_f32 v223, v223
  v_exp_f32 v192, v192
  v_exp_f32 v193, v193
  v_smfmac_f32_32x32x32_bf16 v[240:255], v[180:183], v[216:223], v7
  s_cbranch_scc0 L_NX1_R
  s_mov_b32 s65, 524288
L_NXT_P:
  s_waitcnt vmcnt(0)
  v_cmp_gt_u32 vcc, 1, v5
  s_sub_u32 s65, s65, 1
  s_cbranch_scc1 L_NXT_OK
  s_and_b64 vcc, vcc, exec
  s_cbranch_scc0 L_NXT_OK
  s_sleep 2
  buffer_load_dword v5, v31, s[12:15], s60 offen sc1
  s_branch L_NXT_P
L_NXT_OK:
L_NX1_R:
  s_waitcnt vmcnt(0)
  s_barrier
  v_xor_b32 v2, 0x18000, v2
  v_xor_b32 v3, 0x18000, v3
  s_setprio 3
  s_mov_b64 exec, s[66:67]
  ds_read_b128 v[176:179], v3 offset:0
  ds_read_b128 v[180:183], v3 offset:512
  s_mov_b64 exec, -1
  ds_read_b128 v[32:35], v2 offset:0
  v_exp_f32 v194, v194
  v_exp_f32 v195, v195
  v_exp_f32 v196, v196
  v_mfma_f32_32x32x16_bf16 v[208:223], v[36:39], v[12:15], 0
  v_exp_f32 v197, v197
  v_exp_f32 v198, v198
  v_exp_f32 v199, v199
  v_exp_f32 v200, v200
  v_exp_f32 v201, v201
  v_smfmac_f32_32x32x32_bf16 v[224:239], v[184:187], v[192:199], v7
  v_exp_f32 v202, v202
  v_exp_f32 v203, v203
  v_exp_f32 v204, v204
  v_exp_f32 v205, v205
  v_exp_f32 v206, v206
  v_exp_f32 v207, v207
  v_exp_f32 v208, v208
  v_exp_f32 v209, v209
  v_smfmac_f32_32x32x32_bf16 v[224:239], v[188:191], v[200:207], v7
  v_exp_f32 v210, v210
  v_exp_f32 v211, v211
  v_exp_f32 v212, v212
  s_waitcnt lgkmcnt(0)
  v_mfma_f32_32x32x16_bf16 v[192:207], v[32:35], v[8:11], 0
  v_exp_f32 v213, v213
  v_exp_f32 v214, v214
  v_exp_f32 v215, v215
  v_exp_f32 v216, v216
  v_exp_f32 v217, v217
  v_smfmac_f32_32x32x32_bf16 v[240:255], v[184:187], v[208:215], v7
  v_exp_f32 v218, v218
  v_exp_f32 v219, v219
  v_exp_f32 v220, v220
  v_exp_f32 v221, v221
  v_exp_f32 v222, v222
  v_exp_f32 v223, v223
  v_exp_f32 v192, v192
  v_exp_f32 v193, v193
  v_smfmac_f32_32x32x32_bf16 v[240:255], v[188:191], v[216:223], v7
  s_mov_b64 exec, s[66:67]
  ds_read_b128 v[184:187], v3 offset:2048
  ds_read_b128 v[188:191], v3 offset:2560
  s_mov_b64 exec, -1
  ds_read_b128 v[36:39], v2 offset:2048
  v_exp_f32 v194, v194
  v_exp_f32 v195, v195
  v_exp_f32 v196, v196
  v_mfma_f32_32x32x16_bf16 v[208:223], v[32:35], v[12:15], 0
  s_add_u32 s96, s96, 1
  s_and_b32 s96, s96, 7
  s_lshl_b32 s62, s96, 14
  s_mov_b32 m0, s95
  s_add_u32 s62, s62, s94
  buffer_load_dwordx4 v4, s[12:15], s62 offen offset:0 sc1 lds
  v_exp_f32 v197, v197
  v_exp_f32 v198, v198
  v_exp_f32 v199, v199
  v_exp_f32 v200, v200
  v_exp_f32 v201, v201
  v_smfmac_f32_32x32x32_bf16 v[224:239], v[176:179], v[192:199], v7
  v_exp_f32 v202, v202
  v_exp_f32 v203, v203
  v_exp_f32 v204, v204
  v_exp_f32 v205, v205
  v_exp_f32 v206, v206
  v_exp_f32 v207, v207
  v_exp_f32 v208, v208
  v_exp_f32 v209, v209
  v_smfmac_f32_32x32x32_bf16 v[224:239], v[180:183], v[200:207], v7
  v_exp_f32 v210, v210
  v_exp_f32 v211, v211
  v_exp_f32 v212, v212
  s_waitcnt lgkmcnt(0)
  v_mfma_f32_32x32x16_bf16 v[192:207], v[36:39], v[8:11], 0
  v_exp_f32 v213, v213
  v_exp_f32 v214, v214
  v_exp_f32 v215, v215
  v_exp_f32 v216, v216
  v_exp_f32 v217, v217
  v_smfmac_f32_32x32x32_bf16 v[240:255], v[176:179], v[208:215], v7
  v_exp_f32 v218, v218
  v_exp_f32 v219, v219
  v_exp_f32 v220, v220
  v_exp_f32 v221, v221
  v_exp_f32 v222, v222
  v_exp_f32 v223, v223
  v_exp_f32 v192, v192
  v_exp_f32 v193, v193
  v_smfmac_f32_32x32x32_bf16 v[240:255], v[180:183], v[216:223], v7
  s_mov_b64 exec, s[66:67]
  ds_read_b128 v[176:179], v3 offset:4096
  ds_read_b128 v[180:183], v3 offset:4608
  s_mov_b64 exec, -1
  ds_read_b128 v[32:35], v2 offset:4096
  v_exp_f32 v194, v194
  v_exp_f32 v195, v195
  v_exp_f32 v196, v196
  v_mfma_f32_32x32x16_bf16 v[208:223], v[36:39], v[12:15], 0
  buffer_load_dwordx4 v4, s[12:15], s62 offen offset:1024 sc1 lds
  v_exp_f32 v197, v197
  v_exp_f32 v198, v198
  v_exp_f32 v199, v199
  v_exp_f32 v200, v200
  v_exp_f32 v201, v201
  v_smfmac_f32_32x32x32_bf16 v[224:239], v[184:187], v[192:199], v7
  v_exp_f32 v202, v202
  v_exp_f32 v203, v203
  v_exp_f32 v204, v204
  v_exp_f32 v205, v205
  v_exp_f32 v206, v206
  v_exp_f32 v207, v207
  v_exp_f32 v208, v208
  v_exp_f32 v209, v209
  v_smfmac_f32_32x32x32_bf16 v[224:239], v[188:191], v[200:207], v7
  v_exp_f32 v210, v210
  v_exp_f32 v211, v211
  v_exp_f32 v212, v212
  s_waitcnt lgkmcnt(0)
  v_mfma_f32_32x32x16_bf16 v[192:207], v[32:35], v[8:11], 0
  v_mov_b32 v40, -1
  v_mov_b32 v41, -1
  v_mov_b32 v42, -1
  v_mov_b32 v43, -1
  buffer_store_dwordx4 v[40:43], v4, s[12:15], s98 offen offset:0 sc1
  buffer_store_dwordx4 v[40:43], v4, s[12:15], s98 offen offset:1024 sc1
  v_exp_f32 v213, v213
  v_exp_f32 v214, v214
  v_exp_f32 v215, v215
  v_exp_f32 v216, v216
  v_exp_f32 v217, v217
  v_smfmac_f32_32x32x32_bf16 v[240:255], v[184:187], v[208:215], v7
  v_exp_f32 v218, v218
  v_exp_f32 v219, v219
  v_exp_f32 v220, v220
  v_exp_f32 v221, v221
  v_exp_f32 v222, v222
  v_exp_f32 v223, v223
  v_exp_f32 v192, v192
  v_exp_f32 v193, v193
  v_smfmac_f32_32x32x32_bf16 v[240:255], v[188:191], v[216:223], v7
  s_mov_b64 exec, s[66:67]
  ds_read_b128 v[184:187], v3 offset:6144
  ds_read_b128 v[188:191], v3 offset:6656
  s_mov_b64 exec, -1
  ds_read_b128 v[36:39], v2 offset:6144
  v_exp_f32 v194, v194
  v_exp_f32 v195, v195
  v_exp_f32 v196, v196
  v_mfma_f32_32x32x16_bf16 v[208:223], v[32:35], v[12:15], 0
  buffer_load_dwordx4 v4, s[12:15], s62 offen offset:2048 sc1 lds
  v_exp_f32 v197, v197
  v_exp_f32 v198, v198
  v_exp_f32 v199, v199
  v_exp_f32 v200, v200
  v_exp_f32 v201, v201
  v_smfmac_f32_32x32x32_bf16 v[224:239], v[176:179], v[192:199], v7
  v_exp_f32 v202, v202
  v_exp_f32 v203, v203
  v_exp_f32 v204, v204
  v_exp_f32 v205, v205
  v_exp_f32 v206, v206
  v_exp_f32 v207, v207
  v_exp_f32 v208, v208
  v_exp_f32 v209, v209
  v_smfmac_f32_32x32x32_bf16 v[224:239], v[180:183], v[200:207], v7
  v_exp_f32 v210, v210
  v_exp_f32 v211, v211
  v_exp_f32 v212, v212
  s_waitcnt lgkmcnt(0)
  v_mfma_f32_32x32x16_bf16 v[192:207], v[36:39], v[8:11], 0
  v_exp_f32 v213, v213
  v_exp_f32 v214, v214
  v_exp_f32 v215, v215
  v_exp_f32 v216, v216
  v_exp_f32 v217, v217
  v_smfmac_f32_32x32x32_bf16 v[240:255], v[176:179], v[208:215], v7
  v_exp_f32 v218, v218
  v_exp_f32 v219, v219
  v_exp_f32 v220, v220
  v_exp_f32 v221, v221
  v_exp_f32 v222, v222
  v_exp_f32 v223, v223
  v_exp_f32 v192, v192
  v_exp_f32 v193, v193
  v_smfmac_f32_32x32x32_bf16 v[240:255], v[180:183], v[216:223], v7
  s_mov_b64 exec, s[66:67]
  ds_read_b128 v[176:179], v3 offset:8192
  ds_read_b128 v[180:183], v3 offset:8704
  s_mov_b64 exec, -1
  ds_read_b128 v[32:35], v2 offset:8192
  v_exp_f32 v194, v194
  v_exp_f32 v195, v195
  v_exp_f32 v196, v196
  v_mfma_f32_32x32x16_bf16 v[208:223], v[36:39], v[12:15], 0
  buffer_load_dwordx4 v4, s[12:15], s62 offen offset:3072 sc1 lds
  s_xor_b32 s95, s95, 0x18000
  v_exp_f32 v197, v197
  v_exp_f32 v198, v198
  v_exp_f32 v199, v199
  v_exp_f32 v200, v200
  v_exp_f32 v201, v201
  v_smfmac_f32_32x32x32_bf16 v[224:239], v[184:187], v[192:199], v7
  s_cmp_eq_u32 s56, 4
  v_exp_f32 v202, v202
  v_exp_f32 v203, v203
  v_exp_f32 v204, v204
  v_exp_f32 v205, v205
  v_exp_f32 v206, v206
  v_exp_f32 v207, v207
  v_exp_f32 v208, v208
  v_exp_f32 v209, v209
  v_smfmac_f32_32x32x32_bf16 v[224:239], v[188:191], v[200:207], v7
  s_cbranch_scc0 L_AL0_R
  s_lshl_b32 s63, s57, 11
  s_add_u32 s63, s63, 16777216
  v_bfe_u32 v5, v0, 2, 3
  v_lshl_add_u32 v31, v5, 8, v31
  buffer_load_dword v5, v31, s[12:15], s63 offen sc1
L_AL0_R:
  s_setprio 2
  v_exp_f32 v210, v210
  v_exp_f32 v211, v211
  v_exp_f32 v212, v212
  s_waitcnt lgkmcnt(0)
  v_mfma_f32_32x32x16_bf16 v[192:207], v[32:35], v[8:11], 0
  v_exp_f32 v213, v213
  v_exp_f32 v214, v214
  v_exp_f32 v215, v215
  v_exp_f32 v216, v216
  v_exp_f32 v217, v217
  v_smfmac_f32_32x32x32_bf16 v[240:255], v[184:187], v[208:215], v7
  v_exp_f32 v218, v218
  v_exp_f32 v219, v219
  v_exp_f32 v220, v220
  v_exp_f32 v221, v221
  v_exp_f32 v222, v222
  v_exp_f32 v223, v223
  v_exp_f32 v192, v192
  v_exp_f32 v193, v193
  v_smfmac_f32_32x32x32_bf16 v[240:255], v[188:191], v[216:223], v7
  s_mov_b64 exec, s[66:67]
  ds_read_b128 v[184:187], v3 offset:10240
  ds_read_b128 v[188:191], v3 offset:10752
  s_mov_b64 exec, -1
  ds_read_b128 v[36:39], v2 offset:10240
  v_exp_f32 v194, v194
  v_exp_f32 v195, v195
  v_exp_f32 v196, v196
  v_mfma_f32_32x32x16_bf16 v[208:223], v[32:35], v[12:15], 0
  s_cmp_lt_u32 s99, 4
  s_cselect_b32 s60, s32, s48
  s_lshl_b32 s61, s99, 11
  s_add_u32 m0, s60, s61
  s_and_b32 s61, s55, 7
  s_lshr_b32 s55, s55, 4
  s_cmp_lt_u32 s61, 4
  s_cselect_b32 s28, s40, s46
  s_cselect_b32 s29, s41, s47
  s_and_b32 s61, s61, 3
  s_lshl_b32 s61, s61, 17
  s_add_u32 s61, s61, s49
  s_add_u32 s99, s99, 1
  buffer_load_dwordx4 v28, s[28:31], s61 offen lds
  v_exp_f32 v197, v197
  v_exp_f32 v198, v198
  v_exp_f32 v199, v199
  v_exp_f32 v200, v200
  v_exp_f32 v201, v201
  v_smfmac_f32_32x32x32_bf16 v[224:239], v[176:179], v[192:199], v7
  v_exp_f32 v202, v202
  v_exp_f32 v203, v203
  v_exp_f32 v204, v204
  v_exp_f32 v205, v205
  v_exp_f32 v206, v206
  v_exp_f32 v207, v207
  v_exp_f32 v208, v208
  v_exp_f32 v209, v209
  v_smfmac_f32_32x32x32_bf16 v[224:239], v[180:183], v[200:207], v7
  v_exp_f32 v210, v210
  v_exp_f32 v211, v211
  v_exp_f32 v212, v212
  s_waitcnt lgkmcnt(0)
  v_mfma_f32_32x32x16_bf16 v[192:207], v[36:39], v[8:11], 0
  v_exp_f32 v213, v213
  v_exp_f32 v214, v214
  v_exp_f32 v215, v215
  v_exp_f32 v216, v216
  v_exp_f32 v217, v217
  v_smfmac_f32_32x32x32_bf16 v[240:255], v[176:179], v[208:215], v7
  v_exp_f32 v218, v218
  v_exp_f32 v219, v219
  v_exp_f32 v220, v220
  v_exp_f32 v221, v221
  v_exp_f32 v222, v222
  v_exp_f32 v223, v223
  v_exp_f32 v192, v192
  v_exp_f32 v193, v193
  v_smfmac_f32_32x32x32_bf16 v[240:255], v[180:183], v[216:223], v7
  s_mov_b64 exec, s[66:67]
  ds_read_b128 v[176:179], v3 offset:12288
  ds_read_b128 v[180:183], v3 offset:12800
  s_mov_b64 exec, -1
  ds_read_b128 v[32:35], v2 offset:12288
  v_exp_f32 v194, v194
  v_exp_f32 v195, v195
  v_exp_f32 v196, v196
  v_mfma_f32_32x32x16_bf16 v[208:223], v[36:39], v[12:15], 0
  s_add_u32 m0, m0, 1024
  s_add_u32 s61, s61, 8192
  buffer_load_dwordx4 v28, s[28:31], s61 offen lds
  v_exp_f32 v197, v197
  v_exp_f32 v198, v198
  v_exp_f32 v199, v199
  v_exp_f32 v200, v200
  v_exp_f32 v201, v201
  v_smfmac_f32_32x32x32_bf16 v[224:239], v[184:187], v[192:199], v7
  v_exp_f32 v202, v202
  v_exp_f32 v203, v203
  v_exp_f32 v204, v204
  v_exp_f32 v205, v205
  v_exp_f32 v206, v206
  v_exp_f32 v207, v207
  v_exp_f32 v208, v208
  v_exp_f32 v209, v209
  v_smfmac_f32_32x32x32_bf16 v[224:239], v[188:191], v[200:207], v7
  s_setprio 1
  v_exp_f32 v210, v210
  v_exp_f32 v211, v211
  v_exp_f32 v212, v212
  s_waitcnt lgkmcnt(0)
  v_mfma_f32_32x32x16_bf16 v[192:207], v[32:35], v[8:11], 0
  v_exp_f32 v213, v213
  v_exp_f32 v214, v214
  v_exp_f32 v215, v215
  v_exp_f32 v216, v216
  v_exp_f32 v217, v217
  v_smfmac_f32_32x32x32_bf16 v[240:255], v[184:187], v[208:215], v7
  v_exp_f32 v218, v218
  v_exp_f32 v219, v219
  v_exp_f32 v220, v220
  v_exp_f32 v221, v221
  v_exp_f32 v222, v222
  v_exp_f32 v223, v223
  v_exp_f32 v192, v192
  v_exp_f32 v193, v193
  v_smfmac_f32_32x32x32_bf16 v[240:255], v[188:191], v[216:223], v7
  s_mov_b64 exec, s[66:67]
  ds_read_b128 v[184:187], v3 offset:14336
  ds_read_b128 v[188:191], v3 offset:14848
  s_mov_b64 exec, -1
  ds_read_b128 v[36:39], v2 offset:14336
  v_exp_f32 v194, v194
  v_exp_f32 v195, v195
  v_exp_f32 v196, v196
  v_mfma_f32_32x32x16_bf16 v[208:223], v[32:35], v[12:15], 0
  v_exp_f32 v197, v197
  v_exp_f32 v198, v198
  v_exp_f32 v199, v199
  v_exp_f32 v200, v200
  v_exp_f32 v201, v201
  v_smfmac_f32_32x32x32_bf16 v[224:239], v[176:179], v[192:199], v7
  s_cmp_eq_u32 s56, 4
  s_setprio 0
  v_exp_f32 v202, v202
  v_exp_f32 v203, v203
  v_exp_f32 v204, v204
  v_exp_f32 v205, v205
  v_exp_f32 v206, v206
  v_exp_f32 v207, v207
  v_exp_f32 v208, v208
  v_exp_f32 v209, v209
  v_smfmac_f32_32x32x32_bf16 v[224:239], v[180:183], v[200:207], v7
  s_cbranch_scc0 L_AL1_R
  s_waitcnt vmcnt(2)
  v_cmp_gt_u32 vcc, 1, v5
  s_lshl_b32 s63, s57, 11
  s_add_u32 s63, s63, 16777216
  s_and_b64 vcc, vcc, exec
  s_cbranch_scc0 L_ALL_OK
  s_mov_b32 s65, 524288
L_ALL_P:
  s_waitcnt vmcnt(0)
  v_cmp_gt_u32 vcc, 1, v5
  s_sub_u32 s65, s65, 1
  s_cbranch_scc1 L_ALL_OK
  s_and_b64 vcc, vcc, exec
  s_cbranch_scc0 L_ALL_OK
  s_sleep 2
  buffer_load_dword v5, v31, s[12:15], s63 offen sc1
  s_branch L_ALL_P
L_ALL_OK:
L_AL1_R:
  v_exp_f32 v210, v210
  v_exp_f32 v211, v211
  v_exp_f32 v212, v212
  s_waitcnt lgkmcnt(0)
  v_mfma_f32_32x32x16_bf16 v[192:207], v[36:39], v[8:11], 0
  v_exp_f32 v213, v213
  v_exp_f32 v214, v214
  v_exp_f32 v215, v215
  v_exp_f32 v216, v216
  v_exp_f32 v217, v217
  v_smfmac_f32_32x32x32_bf16 v[240:255], v[176:179], v[208:215], v7
  s_waitcnt vmcnt(2)
  s_barrier
  s_setprio 3
  v_exp_f32 v218, v218
  v_exp_f32 v219, v219
  v_exp_f32 v220, v220
  v_exp_f32 v221, v221
  v_exp_f32 v222, v222
  v_exp_f32 v223, v223
  v_exp_f32 v192, v192
  v_exp_f32 v193, v193
  v_smfmac_f32_32x32x32_bf16 v[240:255], v[180:183], v[216:223], v7
  v_xor_b32 v2, 0x18000, v2
  v_xor_b32 v3, 0x18000, v3
  s_mov_b64 exec, s[66:67]
  ds_read_b128 v[176:179], v3 offset:0
  ds_read_b128 v[180:183], v3 offset:512
  s_mov_b64 exec, -1
  ds_read_b128 v[32:35], v2 offset:0
  v_exp_f32 v194, v194
  v_exp_f32 v195, v195
  v_exp_f32 v196, v196
  v_mfma_f32_32x32x16_bf16 v[208:223], v[36:39], v[12:15], 0
  v_exp_f32 v197, v197
  v_exp_f32 v198, v198
  v_exp_f32 v199, v199
  v_exp_f32 v200, v200
  v_exp_f32 v201, v201
  v_smfmac_f32_32x32x32_bf16 v[224:239], v[184:187], v[192:199], v7
  v_exp_f32 v202, v202
  v_exp_f32 v203, v203
  v_exp_f32 v204, v204
  v_exp_f32 v205, v205
  v_exp_f32 v206, v206
  v_exp_f32 v207, v207
  v_exp_f32 v208, v208
  v_exp_f32 v209, v209
  v_smfmac_f32_32x32x32_bf16 v[224:239], v[188:191], v[200:207], v7
  s_waitcnt vmcnt(0)
  s_mov_b64 exec, 1
  buffer_atomic_add v30, v29, s[12:15], s54 offen
  s_mov_b64 exec, -1
  v_exp_f32 v210, v210
  v_exp_f32 v211, v211
  v_exp_f32 v212, v212
  s_waitcnt lgkmcnt(0)
  v_mfma_f32_32x32x16_bf16 v[192:207], v[32:35], v[8:11], 0
  v_exp_f32 v213, v213
  v_exp_f32 v214, v214
  v_exp_f32 v215, v215
  v_exp_f32 v216, v216
  v_exp_f32 v217, v217
  v_smfmac_f32_32x32x32_bf16 v[240:255], v[184:187], v[208:215], v7
  v_exp_f32 v218, v218
  v_exp_f32 v219, v219
  v_exp_f32 v220, v220
  v_exp_f32 v221, v221
  v_exp_f32 v222, v222
  v_exp_f32 v223, v223
  s_mov_b32 s65, 5
.p2align 3
L_ALOOP:
  v_exp_f32 v192, v192
  v_exp_f32 v193, v193
  v_smfmac_f32_32x32x32_bf16 v[240:255], v[188:191], v[216:223], v7
  s_mov_b64 exec, s[66:67]
  ds_read_b128 v[184:187], v3 offset:2048
  ds_read_b128 v[188:191], v3 offset:2560
  s_mov_b64 exec, -1
  ds_read_b128 v[36:39], v2 offset:2048
  v_exp_f32 v194, v194
  v_exp_f32 v195, v195
  v_exp_f32 v196, v196
  v_mfma_f32_32x32x16_bf16 v[208:223], v[32:35], v[12:15], 0
  s_add_u32 s96, s96, 1
  s_and_b32 s96, s96, 7
  s_lshl_b32 s62, s96, 14
  s_mov_b32 m0, s95
  s_add_u32 s62, s62, s94
  buffer_load_dwordx4 v4, s[12:15], s62 offen offset:0 sc1 lds
  v_exp_f32 v197, v197
  v_exp_f32 v198, v198
  v_exp_f32 v199, v199
  v_exp_f32 v200, v200
  v_exp_f32 v201, v201
  v_smfmac_f32_32x32x32_bf16 v[224:239], v[176:179], v[192:199], v7
  v_exp_f32 v202, v202
  v_exp_f32 v203, v203
  v_exp_f32 v204, v204
  v_exp_f32 v205, v205
  v_exp_f32 v206, v206
  v_exp_f32 v207, v207
  v_exp_f32 v208, v208
  v_exp_f32 v209, v209
  v_smfmac_f32_32x32x32_bf16 v[224:239], v[180:183], v[200:207], v7
  v_exp_f32 v210, v210
  v_exp_f32 v211, v211
  v_exp_f32 v212, v212
  s_waitcnt lgkmcnt(0)
  v_mfma_f32_32x32x16_bf16 v[192:207], v[36:39], v[8:11], 0
  v_exp_f32 v213, v213
  v_exp_f32 v214, v214
  v_exp_f32 v215, v215
  v_exp_f32 v216, v216
  v_exp_f32 v217, v217
  v_smfmac_f32_32x32x32_bf16 v[240:255], v[176:179], v[208:215], v7
  v_exp_f32 v218, v218
  v_exp_f32 v219, v219
  v_exp_f32 v220, v220
  v_exp_f32 v221, v221
  v_exp_f32 v222, v222
  v_exp_f32 v223, v223
  v_exp_f32 v192, v192
  v_exp_f32 v193, v193
  v_smfmac_f32_32x32x32_bf16 v[240:255], v[180:183], v[216:223], v7
  s_mov_b64 exec, s[66:67]
  ds_read_b128 v[176:179], v3 offset:4096
  ds_read_b128 v[180:183], v3 offset:4608
  s_mov_b64 exec, -1
  ds_read_b128 v[32:35], v2 offset:4096
  v_exp_f32 v194, v194
  v_exp_f32 v195, v195
  v_exp_f32 v196, v196
  v_mfma_f32_32x32x16_bf16 v[208:223], v[36:39], v[12:15], 0
  buffer_load_dwordx4 v4, s[12:15], s62 offen offset:1024 sc1 lds
  v_exp_f32 v197, v197
  v_exp_f32 v198, v198
  v_exp_f32 v199, v199
  v_exp_f32 v200, v200
  v_exp_f32 v201, v201
  v_smfmac_f32_32x32x32_bf16 v[224:239], v[184:187], v[192:199], v7
  v_exp_f32 v202, v202
  v_exp_f32 v203, v203
  v_exp_f32 v204, v204
  v_exp_f32 v205, v205
  v_exp_f32 v206, v206
  v_exp_f32 v207, v207
  v_exp_f32 v208, v208
  v_exp_f32 v209, v209
  v_smfmac_f32_32x32x32_bf16 v[224:239], v[188:191], v[200:207], v7
  v_exp_f32 v210, v210
  v_exp_f32 v211, v211
  v_exp_f32 v212, v212
  s_waitcnt lgkmcnt(0)
  v_mfma_f32_32x32x16_bf16 v[192:207], v[32:35], v[8:11], 0
  v_exp_f32 v213, v213
  v_exp_f32 v214, v214
  v_exp_f32 v215, v215
  v_exp_f32 v216, v216
  v_exp_f32 v217, v217
  v_smfmac_f32_32x32x32_bf16 v[240:255], v[184:187], v[208:215], v7
  v_exp_f32 v218, v218
  v_exp_f32 v219, v219
  v_exp_f32 v220, v220
  v_exp_f32 v221, v221
  v_exp_f32 v222, v222
  v_exp_f32 v223, v223
  v_exp_f32 v192, v192
  v_exp_f32 v193, v193
  v_smfmac_f32_32x32x32_bf16 v[240:255], v[188:191], v[216:223], v7
  s_mov_b64 exec, s[66:67]
  ds_read_b128 v[184:187], v3 offset:6144
  ds_read_b128 v[188:191], v3 offset:6656
  s_mov_b64 exec, -1
  ds_read_b128 v[36:39], v2 offset:6144
  v_exp_f32 v194, v194
  v_exp_f32 v195, v195
  v_exp_f32 v196, v196
  v_mfma_f32_32x32x16_bf16 v[208:223], v[32:35], v[12:15], 0
  buffer_load_dwordx4 v4, s[12:15], s62 offen offset:2048 sc1 lds
  v_exp_f32 v197, v197
  v_exp_f32 v198, v198
  v_exp_f32 v199, v199
  v_exp_f32 v200, v200
  v_exp_f32 v201, v201
  v_smfmac_f32_32x32x32_bf16 v[224:239], v[176:179], v[192:199], v7
  v_exp_f32 v202, v202
  v_exp_f32 v203, v203
  v_exp_f32 v204, v204
  v_exp_f32 v205, v205
  v_exp_f32 v206, v206
  v_exp_f32 v207, v207
  v_exp_f32 v208, v208
  v_exp_f32 v209, v209
  v_smfmac_f32_32x32x32_bf16 v[224:239], v[180:183], v[200:207], v7
  v_exp_f32 v210, v210
  v_exp_f32 v211, v211
  v_exp_f32 v212, v212
  s_waitcnt lgkmcnt(0)
  v_mfma_f32_32x32x16_bf16 v[192:207], v[36:39], v[8:11], 0
  v_exp_f32 v213, v213
  v_exp_f32 v214, v214
  v_exp_f32 v215, v215
  v_exp_f32 v216, v216
  v_exp_f32 v217, v217
  v_smfmac_f32_32x32x32_bf16 v[240:255], v[176:179], v[208:215], v7
  v_exp_f32 v218, v218
  v_exp_f32 v219, v219
  v_exp_f32 v220, v220
  v_exp_f32 v221, v221
  v_exp_f32 v222, v222
  v_exp_f32 v223, v223
  v_exp_f32 v192, v192
  v_exp_f32 v193, v193
  v_smfmac_f32_32x32x32_bf16 v[240:255], v[180:183], v[216:223], v7
  s_mov_b64 exec, s[66:67]
  ds_read_b128 v[176:179], v3 offset:8192
  ds_read_b128 v[180:183], v3 offset:8704
  s_mov_b64 exec, -1
  ds_read_b128 v[32:35], v2 offset:8192
  v_exp_f32 v194, v194
  v_exp_f32 v195, v195
  v_exp_f32 v196, v196
  v_mfma_f32_32x32x16_bf16 v[208:223], v[36:39], v[12:15], 0
  buffer_load_dwordx4 v4, s[12:15], s62 offen offset:3072 sc1 lds
  s_xor_b32 s95, s95, 0x18000
  v_exp_f32 v197, v197
  v_exp_f32 v198, v198
  v_exp_f32 v199, v199
  v_exp_f32 v200, v200
  v_exp_f32 v201, v201
  v_smfmac_f32_32x32x32_bf16 v[224:239], v[184:187], v[192:199], v7
  v_exp_f32 v202, v202
  v_exp_f32 v203, v203
  v_exp_f32 v204, v204
  v_exp_f32 v205, v205
  v_exp_f32 v206, v206
  v_exp_f32 v207, v207
  v_exp_f32 v208, v208
  v_exp_f32 v209, v209
  v_smfmac_f32_32x32x32_bf16 v[224:239], v[188:191], v[200:207], v7
  s_setprio 2
  v_exp_f32 v210, v210
  v_exp_f32 v211, v211
  v_exp_f32 v212, v212
  s_waitcnt lgkmcnt(0)
  v_mfma_f32_32x32x16_bf16 v[192:207], v[32:35], v[8:11], 0
  v_exp_f32 v213, v213
  v_exp_f32 v214, v214
  v_exp_f32 v215, v215
  v_exp_f32 v216, v216
  v_exp_f32 v217, v217
  v_smfmac_f32_32x32x32_bf16 v[240:255], v[184:187], v[208:215], v7
  v_exp_f32 v218, v218
  v_exp_f32 v219, v219
  v_exp_f32 v220, v220
  v_exp_f32 v221, v221
  v_exp_f32 v222, v222
  v_exp_f32 v223, v223
  v_exp_f32 v192, v192
  v_exp_f32 v193, v193
  v_smfmac_f32_32x32x32_bf16 v[240:255], v[188:191], v[216:223], v7
  s_mov_b64 exec, s[66:67]
  ds_read_b128 v[184:187], v3 offset:10240
  ds_read_b128 v[188:191], v3 offset:10752
  s_mov_b64 exec, -1
  ds_read_b128 v[36:39], v2 offset:10240
  v_exp_f32 v194, v194
  v_exp_f32 v195, v195
  v_exp_f32 v196, v196
  v_mfma_f32_32x32x16_bf16 v[208:223], v[32:35], v[12:15], 0
  s_cmp_lt_u32 s99, 4
  s_cselect_b32 s60, s32, s48
  s_lshl_b32 s61, s99, 11
  s_add_u32 m0, s60, s61
  s_and_b32 s61, s55, 7
  s_lshr_b32 s55, s55, 4
  s_cmp_lt_u32 s61, 4
  s_cselect_b32 s28, s40, s46
  s_cselect_b32 s29, s41, s47
  s_and_b32 s61, s61, 3
  s_lshl_b32 s61, s61, 17
  s_add_u32 s61, s61, s49
  s_add_u32 s99, s99, 1
  buffer_load_dwordx4 v28, s[28:31], s61 offen lds
  v_exp_f32 v197, v197
  v_exp_f32 v198, v198
  v_exp_f32 v199, v199
  v_exp_f32 v200, v200
  v_exp_f32 v201, v201
  v_smfmac_f32_32x32x32_bf16 v[224:239], v[176:179], v[192:199], v7
  v_exp_f32 v202, v202
  v_exp_f32 v203, v203
  v_exp_f32 v204, v204
  v_exp_f32 v205, v205
  v_exp_f32 v206, v206
  v_exp_f32 v207, v207
  v_exp_f32 v208, v208
  v_exp_f32 v209, v209
  v_smfmac_f32_32x32x32_bf16 v[224:239], v[180:183], v[200:207], v7
  v_exp_f32 v210, v210
  v_exp_f32 v211, v211
  v_exp_f32 v212, v212
  s_waitcnt lgkmcnt(0)
  v_mfma_f32_32x32x16_bf16 v[192:207], v[36:39], v[8:11], 0
  v_exp_f32 v213, v213
  v_exp_f32 v214, v214
  v_exp_f32 v215, v215
  v_exp_f32 v216, v216
  v_exp_f32 v217, v217
  v_smfmac_f32_32x32x32_bf16 v[240:255], v[176:179], v[208:215], v7
  v_exp_f32 v218, v218
  v_exp_f32 v219, v219
  v_exp_f32 v220, v220
  v_exp_f32 v221, v221
  v_exp_f32 v222, v222
  v_exp_f32 v223, v223
  v_exp_f32 v192, v192
  v_exp_f32 v193, v193
  v_smfmac_f32_32x32x32_bf16 v[240:255], v[180:183], v[216:223], v7
  s_mov_b64 exec, s[66:67]
  ds_read_b128 v[176:179], v3 offset:12288
  ds_read_b128 v[180:183], v3 offset:12800
  s_mov_b64 exec, -1
  ds_read_b128 v[32:35], v2 offset:12288
  v_exp_f32 v194, v194
  v_exp_f32 v195, v195
  v_exp_f32 v196, v196
  v_mfma_f32_32x32x16_bf16 v[208:223], v[36:39], v[12:15], 0
  s_add_u32 m0, m0, 1024
  s_add_u32 s61, s61, 8192
  buffer_load_dwordx4 v28, s[28:31], s61 offen lds
  v_exp_f32 v197, v197
  v_exp_f32 v198, v198
  v_exp_f32 v199, v199
  v_exp_f32 v200, v200
  v_exp_f32 v201, v201
  v_smfmac_f32_32x32x32_bf16 v[224:239], v[184:187], v[192:199], v7
  v_exp_f32 v202, v202
  v_exp_f32 v203, v203
  v_exp_f32 v204, v204
  v_exp_f32 v205, v205
  v_exp_f32 v206, v206
  v_exp_f32 v207, v207
  v_exp_f32 v208, v208
  v_exp_f32 v209, v209
  v_smfmac_f32_32x32x32_bf16 v[224:239], v[188:191], v[200:207], v7
  s_setprio 1
  v_exp_f32 v210, v210
  v_exp_f32 v211, v211
  v_exp_f32 v212, v212
  s_waitcnt lgkmcnt(0)
  v_mfma_f32_32x32x16_bf16 v[192:207], v[32:35], v[8:11], 0
  v_exp_f32 v213, v213
  v_exp_f32 v214, v214
  v_exp_f32 v215, v215
  v_exp_f32 v216, v216
  v_exp_f32 v217, v217
  v_smfmac_f32_32x32x32_bf16 v[240:255], v[184:187], v[208:215], v7
  v_exp_f32 v218, v218
  v_exp_f32 v219, v219
  v_exp_f32 v220, v220
  v_exp_f32 v221, v221
  v_exp_f32 v222, v222
  v_exp_f32 v223, v223
  v_exp_f32 v192, v192
  v_exp_f32 v193, v193
  v_smfmac_f32_32x32x32_bf16 v[240:255], v[188:191], v[216:223], v7
  s_mov_b64 exec, s[66:67]
  ds_read_b128 v[184:187], v3 offset:14336
  ds_read_b128 v[188:191], v3 offset:14848
  s_mov_b64 exec, -1
  ds_read_b128 v[36:39], v2 offset:14336
  v_exp_f32 v194, v194
  v_exp_f32 v195, v195
  v_exp_f32 v196, v196
  v_mfma_f32_32x32x16_bf16 v[208:223], v[32:35], v[12:15], 0
  v_exp_f32 v197, v197
  v_exp_f32 v198, v198
  v_exp_f32 v199, v199
  v_exp_f32 v200, v200
  v_exp_f32 v201, v201
  v_smfmac_f32_32x32x32_bf16 v[224:239], v[176:179], v[192:199], v7
  s_setprio 0
  v_exp_f32 v202, v202
  v_exp_f32 v203, v203
  v_exp_f32 v204, v204
  v_exp_f32 v205, v205
  v_exp_f32 v206, v206
  v_exp_f32 v207, v207
  v_exp_f32 v208, v208
  v_exp_f32 v209, v209
  v_smfmac_f32_32x32x32_bf16 v[224:239], v[180:183], v[200:207], v7
  v_exp_f32 v210, v210
  v_exp_f32 v211, v211
  v_exp_f32 v212, v212
  s_waitcnt lgkmcnt(0)
  v_mfma_f32_32x32x16_bf16 v[192:207], v[36:39], v[8:11], 0
  v_exp_f32 v213, v213
  v_exp_f32 v214, v214
  v_exp_f32 v215, v215
  v_exp_f32 v216, v216
  v_exp_f32 v217, v217
  v_smfmac_f32_32x32x32_bf16 v[240:255], v[176:179], v[208:215], v7
  s_waitcnt vmcnt(2)
  s_barrier
  s_setprio 3
  v_exp_f32 v218, v218
  v_exp_f32 v219, v219
  v_exp_f32 v220, v220
  v_exp_f32 v221, v221
  v_exp_f32 v222, v222
  v_exp_f32 v223, v223
  v_exp_f32 v192, v192
  v_exp_f32 v193, v193
  v_smfmac_f32_32x32x32_bf16 v[240:255], v[180:183], v[216:223], v7
  v_xor_b32 v2, 0x18000, v2
  v_xor_b32 v3, 0x18000, v3
  s_mov_b64 exec, s[66:67]
  ds_read_b128 v[176:179], v3 offset:0
  ds_read_b128 v[180:183], v3 offset:512
  s_mov_b64 exec, -1
  ds_read_b128 v[32:35], v2 offset:0
  v_exp_f32 v194, v194
  v_exp_f32 v195, v195
  v_exp_f32 v196, v196
  v_mfma_f32_32x32x16_bf16 v[208:223], v[36:39], v[12:15], 0
  v_exp_f32 v197, v197
  v_exp_f32 v198, v198
  v_exp_f32 v199, v199
  v_exp_f32 v200, v200
  v_exp_f32 v201, v201
  v_smfmac_f32_32x32x32_bf16 v[224:239], v[184:187], v[192:199], v7
  v_exp_f32 v202, v202
  v_exp_f32 v203, v203
  v_exp_f32 v204, v204
  v_exp_f32 v205, v205
  v_exp_f32 v206, v206
  v_exp_f32 v207, v207
  v_exp_f32 v208, v208
  v_exp_f32 v209, v209
  v_smfmac_f32_32x32x32_bf16 v[224:239], v[188:191], v[200:207], v7
  s_sub_u32 s65, s65, 1
  s_cmp_lg_u32 s65, 0
  v_exp_f32 v210, v210
  v_exp_f32 v211, v211
  v_exp_f32 v212, v212
  s_waitcnt lgkmcnt(0)
  v_mfma_f32_32x32x16_bf16 v[192:207], v[32:35], v[8:11], 0
  v_exp_f32 v213, v213
  v_exp_f32 v214, v214
  v_exp_f32 v215, v215
  v_exp_f32 v216, v216
  v_exp_f32 v217, v217
  v_smfmac_f32_32x32x32_bf16 v[240:255], v[184:187], v[208:215], v7
  v_exp_f32 v218, v218
  v_exp_f32 v219, v219
  v_exp_f32 v220, v220
  v_exp_f32 v221, v221
  v_exp_f32 v222, v222
  v_exp_f32 v223, v223
  s_cbranch_scc1 L_ALOOP
  v_exp_f32 v192, v192
  v_exp_f32 v193, v193
  v_smfmac_f32_32x32x32_bf16 v[240:255], v[188:191], v[216:223], v7
  v_and_b32 v31, 48, v4
  v_lshlrev_b32 v31, 4, v31
  s_lshl_b32 s62, s58, 10
  s_add_u32 s62, s62, 16842752
  buffer_load_dword v5, v31, s[12:15], s62 offen sc1
  buffer_load_dword v173, v31, s[12:15], s1 offen sc1
  s_cmp_eq_u32 s68, 1
  s_mov_b64 exec, s[66:67]
  ds_read_b128 v[184:187], v3 offset:2048
  ds_read_b128 v[188:191], v3 offset:2560
  s_mov_b64 exec, -1
  ds_read_b128 v[36:39], v2 offset:2048
  v_exp_f32 v194, v194
  v_exp_f32 v195, v195
  v_exp_f32 v196, v196
  v_mfma_f32_32x32x16_bf16 v[208:223], v[32:35], v[12:15], 0
  v_exp_f32 v197, v197
  v_exp_f32 v198, v198
  v_exp_f32 v199, v199
  v_exp_f32 v200, v200
  v_exp_f32 v201, v201
  v_smfmac_f32_32x32x32_bf16 v[224:239], v[176:179], v[192:199], v7
  s_cbranch_scc0 L_ROLE_R
  s_setprio 1
L_ROLE_R:
  v_exp_f32 v202, v202
  v_exp_f32 v203, v203
  v_exp_f32 v204, v204
  v_exp_f32 v205, v205
  v_exp_f32 v206, v206
  v_exp_f32 v207, v207
  v_exp_f32 v208, v208
  v_exp_f32 v209, v209
  v_smfmac_f32_32x32x32_bf16 v[224:239], v[180:183], v[200:207], v7
  s_lshl_b32 s60, s56, 12
  s_add_u32 m0, s60, 0
  s_mov_b32 s61, s38
  s_cmp_lt_u32 s61, 4
  s_cselect_b32 s28, s40, s46
  s_cselect_b32 s29, s41, s47
  s_and_b32 s61, s61, 3
  s_lshl_b32 s61, s61, 17
  s_add_u32 s61, s61, s49
  buffer_load_dwordx4 v28, s[28:31], s61 offen lds
  v_exp_f32 v210, v210
  v_exp_f32 v211, v211
  v_exp_f32 v212, v212
  s_waitcnt lgkmcnt(0)
  v_mfma_f32_32x32x16_bf16 v[192:207], v[36:39], v[8:11], 0
  s_add_u32 m0, m0, 1024
  s_add_u32 s61, s61, 8192
  buffer_load_dwordx4 v28, s[28:31], s61 offen lds
  v_exp_f32 v213, v213
  v_exp_f32 v214, v214
  v_exp_f32 v215, v215
  v_exp_f32 v216, v216
  v_exp_f32 v217, v217
  v_smfmac_f32_32x32x32_bf16 v[240:255], v[176:179], v[208:215], v7
  s_lshl_b32 s60, s56, 12
  s_add_u32 m0, s60, 2048
  s_mov_b32 s61, s39
  s_cmp_lt_u32 s61, 4
  s_cselect_b32 s28, s40, s46
  s_cselect_b32 s29, s41, s47
  s_and_b32 s61, s61, 3
  s_lshl_b32 s61, s61, 17
  s_add_u32 s61, s61, s49
  buffer_load_dwordx4 v28, s[28:31], s61 offen lds
  v_exp_f32 v218, v218
  v_exp_f32 v219, v219
  v_exp_f32 v220, v220
  v_exp_f32 v221, v221
  v_exp_f32 v222, v222
  v_exp_f32 v223, v223
  v_exp_f32 v192, v192
  v_exp_f32 v193, v193
  v_smfmac_f32_32x32x32_bf16 v[240:255], v[180:183], v[216:223], v7
  s_add_u32 m0, m0, 1024
  s_add_u32 s61, s61, 8192
  buffer_load_dwordx4 v28, s[28:31], s61 offen lds
  s_mov_b64 exec, s[66:67]
  ds_read_b128 v[176:179], v3 offset:4096
  ds_read_b128 v[180:183], v3 offset:4608
  s_mov_b64 exec, -1
  ds_read_b128 v[32:35], v2 offset:4096
  v_exp_f32 v194, v194
  v_exp_f32 v195, v195
  v_exp_f32 v196, v196
  v_mfma_f32_32x32x16_bf16 v[208:223], v[36:39], v[12:15], 0
  v_xor_b32 v171, 64, v6
  s_lshl_b32 s60, s68, 10
  v_add_u32 v174, s60, v4
  v_xor_b32 v175, 0x400, v174
  v_exp_f32 v197, v197
  v_exp_f32 v198, v198
  v_exp_f32 v199, v199
  v_exp_f32 v200, v200
  v_exp_f32 v201, v201
  v_smfmac_f32_32x32x32_bf16 v[224:239], v[184:187], v[192:199], v7
  v_exp_f32 v202, v202
  v_exp_f32 v203, v203
  v_exp_f32 v204, v204
  v_exp_f32 v205, v205
  v_exp_f32 v206, v206
  v_exp_f32 v207, v207
  v_exp_f32 v208, v208
  v_exp_f32 v209, v209
  v_smfmac_f32_32x32x32_bf16 v[224:239], v[188:191], v[200:207], v7
  v_exp_f32 v210, v210
  v_exp_f32 v211, v211
  v_exp_f32 v212, v212
  s_waitcnt lgkmcnt(0)
  v_mfma_f32_32x32x16_bf16 v[192:207], v[32:35], v[8:11], 0
  v_exp_f32 v213, v213
  v_exp_f32 v214, v214
  v_exp_f32 v215, v215
  v_exp_f32 v216, v216
  v_exp_f32 v217, v217
  v_smfmac_f32_32x32x32_bf16 v[240:255], v[184:187], v[208:215], v7
  v_exp_f32 v218, v218
  v_exp_f32 v219, v219
  v_exp_f32 v220, v220
  v_exp_f32 v221, v221
  v_exp_f32 v222, v222
  v_exp_f32 v223, v223
  v_exp_f32 v192, v192
  v_exp_f32 v193, v193
  v_smfmac_f32_32x32x32_bf16 v[240:255], v[188:191], v[216:223], v7
  s_mov_b64 exec, s[66:67]
  ds_read_b128 v[184:187], v3 offset:6144
  ds_read_b128 v[188:191], v3 offset:6656
  s_mov_b64 exec, -1
  ds_read_b128 v[36:39], v2 offset:6144
  v_exp_f32 v194, v194
  v_exp_f32 v195, v195
  v_exp_f32 v196, v196
  v_mfma_f32_32x32x16_bf16 v[208:223], v[32:35], v[12:15], 0
  ds_read_b64_tr_b16 v[40:41], v6 offset:0
  ds_read_b64_tr_b16 v[42:43], v6 offset:1024
  ds_read_b64_tr_b16 v[44:45], v171 offset:0
  ds_read_b64_tr_b16 v[46:47], v171 offset:1024
  v_exp_f32 v197, v197
  v_exp_f32 v198, v198
  v_exp_f32 v199, v199
  v_exp_f32 v200, v200
  v_exp_f32 v201, v201
  v_smfmac_f32_32x32x32_bf16 v[224:239], v[176:179], v[192:199], v7
  ds_read_b64_tr_b16 v[48:49], v6 offset:2048
  ds_read_b64_tr_b16 v[50:51], v6 offset:3072
  ds_read_b64_tr_b16 v[52:53], v171 offset:2048
  ds_read_b64_tr_b16 v[54:55], v171 offset:3072
  v_exp_f32 v202, v202
  v_exp_f32 v203, v203
  v_exp_f32 v204, v204
  v_exp_f32 v205, v205
  v_exp_f32 v206, v206
  v_exp_f32 v207, v207
  v_exp_f32 v208, v208
  v_exp_f32 v209, v209
  v_smfmac_f32_32x32x32_bf16 v[224:239], v[180:183], v[200:207], v7
  v_exp_f32 v210, v210
  v_exp_f32 v211, v211
  v_exp_f32 v212, v212
  s_waitcnt lgkmcnt(0)
  v_mfma_f32_32x32x16_bf16 v[192:207], v[36:39], v[8:11], 0
  ds_read_b64_tr_b16 v[56:57], v6 offset:4096
  ds_read_b64_tr_b16 v[58:59], v6 offset:5120
  ds_read_b64_tr_b16 v[60:61], v171 offset:4096
  ds_read_b64_tr_b16 v[62:63], v171 offset:5120
  v_exp_f32 v213, v213
  v_exp_f32 v214, v214
  v_exp_f32 v215, v215
  v_exp_f32 v216, v216
  v_exp_f32 v217, v217
  v_smfmac_f32_32x32x32_bf16 v[240:255], v[176:179], v[208:215], v7
  ds_read_b64_tr_b16 v[64:65], v6 offset:6144
  ds_read_b64_tr_b16 v[66:67], v6 offset:7168
  ds_read_b64_tr_b16 v[68:69], v171 offset:6144
  ds_read_b64_tr_b16 v[70:71], v171 offset:7168
  v_exp_f32 v218, v218
  v_exp_f32 v219, v219
  v_exp_f32 v220, v220
  v_exp_f32 v221, v221
  v_exp_f32 v222, v222
  v_exp_f32 v223, v223
  v_exp_f32 v192, v192
  v_exp_f32 v193, v193
  v_smfmac_f32_32x32x32_bf16 v[240:255], v[180:183], v[216:223], v7
  s_mov_b64 exec, s[66:67]
  ds_read_b128 v[176:179], v3 offset:8192
  ds_read_b128 v[180:183], v3 offset:8704
  s_mov_b64 exec, -1
  ds_read_b128 v[32:35], v2 offset:8192
  v_exp_f32 v194, v194
  v_exp_f32 v195, v195
  v_exp_f32 v196, v196
  v_mfma_f32_32x32x16_bf16 v[208:223], v[36:39], v[12:15], 0
  v_exp_f32 v197, v197
  v_exp_f32 v198, v198
  v_exp_f32 v199, v199
  v_exp_f32 v200, v200
  v_exp_f32 v201, v201
  v_smfmac_f32_32x32x32_bf16 v[224:239], v[184:187], v[192:199], v7
  s_cmp_eq_u32 s68, 1
  v_exp_f32 v202, v202
  v_exp_f32 v203, v203
  v_exp_f32 v204, v204
  v_exp_f32 v205, v205
  v_exp_f32 v206, v206
  v_exp_f32 v207, v207
  v_exp_f32 v208, v208
  v_exp_f32 v209, v209
  v_smfmac_f32_32x32x32_bf16 v[224:239], v[188:191], v[200:207], v7
  s_cbranch_scc0 L_BW_R
  s_barrier
L_BW_R:
  v_exp_f32 v210, v210
  v_exp_f32 v211, v211
  v_exp_f32 v212, v212
  s_waitcnt lgkmcnt(0)
  v_mfma_f32_32x32x16_bf16 v[192:207], v[32:35], v[8:11], 0
  v_exp_f32 v213, v213
  v_exp_f32 v214, v214
  v_exp_f32 v215, v215
  v_exp_f32 v216, v216
  v_exp_f32 v217, v217
  v_smfmac_f32_32x32x32_bf16 v[240:255], v[184:187], v[208:215], v7
  v_exp_f32 v218, v218
  v_exp_f32 v219, v219
  v_exp_f32 v220, v220
  v_exp_f32 v221, v221
  v_exp_f32 v222, v222
  v_exp_f32 v223, v223
  v_exp_f32 v192, v192
  v_exp_f32 v193, v193
  v_smfmac_f32_32x32x32_bf16 v[240:255], v[188:191], v[216:223], v7
  s_waitcnt vmcnt(4)
  v_min_u32 v5, v5, v173
  v_cmp_gt_u32 vcc, 64, v5
  s_lshl_b32 s62, s58, 10
  s_add_u32 s62, s62, 16842752
  s_and_b64 vcc, vcc, exec
  s_cbranch_scc1 L_GCX
L_GCX_R:
  v_bfe_u32 v31, v4, 2, 7
  buffer_load_dword v168, v31, s[12:15], s0 offen sc1
  buffer_load_dword v169, v31, s[12:15], s0 offen offset:128 sc1
  s_mov_b64 exec, s[66:67]
  ds_read_b128 v[184:187], v3 offset:10240
  ds_read_b128 v[188:191], v3 offset:10752
  s_mov_b64 exec, -1
  ds_read_b128 v[36:39], v2 offset:10240
  v_exp_f32 v194, v194
  v_exp_f32 v195, v195
  v_exp_f32 v196, v196
  v_mfma_f32_32x32x16_bf16 v[208:223], v[32:35], v[12:15], 0
  s_lshl_b32 s60, s56, 12
  s_sub_u32 s60, 98304, s60
  v_add_u32 v6, s60, v6
  v_add_u32 v171, s60, v171
  ds_read_b64_tr_b16 v[72:73], v6 offset:0
  ds_read_b64_tr_b16 v[74:75], v6 offset:1024
  ds_read_b64_tr_b16 v[76:77], v171 offset:0
  ds_read_b64_tr_b16 v[78:79], v171 offset:1024
  v_exp_f32 v197, v197
  v_exp_f32 v198, v198
  v_exp_f32 v199, v199
  v_exp_f32 v200, v200
  v_exp_f32 v201, v201
  v_smfmac_f32_32x32x32_bf16 v[224:239], v[176:179], v[192:199], v7
  v_exp_f32 v202, v202
  v_exp_f32 v203, v203
  v_exp_f32 v204, v204
  v_exp_f32 v205, v205
  v_exp_f32 v206, v206
  v_exp_f32 v207, v207
  v_exp_f32 v208, v208
  v_exp_f32 v209, v209
  v_smfmac_f32_32x32x32_bf16 v[224:239], v[180:183], v[200:207], v7
  v_exp_f32 v210, v210
  v_exp_f32 v211, v211
  v_exp_f32 v212, v212
  s_waitcnt lgkmcnt(0)
  v_mfma_f32_32x32x16_bf16 v[192:207], v[36:39], v[8:11], 0
  ds_read_b64_tr_b16 v[80:81], v6 offset:2048
  ds_read_b64_tr_b16 v[82:83], v6 offset:3072
  ds_read_b64_tr_b16 v[84:85], v171 offset:2048
  ds_read_b64_tr_b16 v[86:87], v171 offset:3072
  v_exp_f32 v213, v213
  v_exp_f32 v214, v214
  v_exp_f32 v215, v215
  v_exp_f32 v216, v216
  v_exp_f32 v217, v217
  v_smfmac_f32_32x32x32_bf16 v[240:255], v[176:179], v[208:215], v7
  v_exp_f32 v218, v218
  v_exp_f32 v219, v219
  v_exp_f32 v220, v220
  v_exp_f32 v221, v221
  v_exp_f32 v222, v222
  v_exp_f32 v223, v223
  v_exp_f32 v192, v192
  v_exp_f32 v193, v193
  v_smfmac_f32_32x32x32_bf16 v[240:255], v[180:183], v[216:223], v7
  s_mov_b64 exec, s[66:67]
  ds_read_b128 v[176:179], v3 offset:12288
  ds_read_b128 v[180:183], v3 offset:12800
  s_mov_b64 exec, -1
  ds_read_b128 v[32:35], v2 offset:12288
  v_exp_f32 v194, v194
  v_exp_f32 v195, v195
  v_exp_f32 v196, v196
  v_mfma_f32_32x32x16_bf16 v[208:223], v[36:39], v[12:15], 0
  v_exp_f32 v197, v197
  v_exp_f32 v198, v198
  v_exp_f32 v199, v199
  v_exp_f32 v200, v200
  v_exp_f32 v201, v201
  v_smfmac_f32_32x32x32_bf16 v[224:239], v[184:187], v[192:199], v7
  v_exp_f32 v202, v202
  v_exp_f32 v203, v203
  v_exp_f32 v204, v204
  v_exp_f32 v205, v205
  v_exp_f32 v206, v206
  v_exp_f32 v207, v207
  v_exp_f32 v208, v208
  v_exp_f32 v209, v209
  v_smfmac_f32_32x32x32_bf16 v[224:239], v[188:191], v[200:207], v7
  v_exp_f32 v210, v210
  v_exp_f32 v211, v211
  v_exp_f32 v212, v212
  s_waitcnt lgkmcnt(0)
  v_mfma_f32_32x32x16_bf16 v[192:207], v[32:35], v[8:11], 0
  v_exp_f32 v213, v213
  v_exp_f32 v214, v214
  v_exp_f32 v215, v215
  v_exp_f32 v216, v216
  v_exp_f32 v217, v217
  v_smfmac_f32_32x32x32_bf16 v[240:255], v[184:187], v[208:215], v7
  v_exp_f32 v218, v218
  v_exp_f32 v219, v219
  v_exp_f32 v220, v220
  v_exp_f32 v221, v221
  v_exp_f32 v222, v222
  v_exp_f32 v223, v223
  v_exp_f32 v192, v192
  v_exp_f32 v193, v193
  v_smfmac_f32_32x32x32_bf16 v[240:255], v[188:191], v[216:223], v7
  s_mov_b64 exec, s[66:67]
  ds_read_b128 v[184:187], v3 offset:14336
  ds_read_b128 v[188:191], v3 offset:14848
  s_mov_b64 exec, -1
  ds_read_b128 v[36:39], v2 offset:14336
  v_exp_f32 v194, v194
  v_exp_f32 v195, v195
  v_exp_f32 v196, v196
  v_mfma_f32_32x32x16_bf16 v[208:223], v[32:35], v[12:15], 0
  v_exp_f32 v197, v197
  v_exp_f32 v198, v198
  v_exp_f32 v199, v199
  v_exp_f32 v200, v200
  v_exp_f32 v201, v201
  v_smfmac_f32_32x32x32_bf16 v[224:239], v[176:179], v[192:199], v7
  v_exp_f32 v202, v202
  v_exp_f32 v203, v203
  v_exp_f32 v204, v204
  v_exp_f32 v205, v205
  v_exp_f32 v206, v206
  v_exp_f32 v207, v207
  v_exp_f32 v208, v208
  v_exp_f32 v209, v209
  v_smfmac_f32_32x32x32_bf16 v[224:239], v[180:183], v[200:207], v7
  v_exp_f32 v210, v210
  v_exp_f32 v211, v211
  v_exp_f32 v212, v212
  s_waitcnt lgkmcnt(0)
  v_mfma_f32_32x32x16_bf16 v[192:207], v[36:39], v[8:11], 0
  v_exp_f32 v213, v213
  v_exp_f32 v214, v214
  v_exp_f32 v215, v215
  v_exp_f32 v216, v216
  v_exp_f32 v217, v217
  v_smfmac_f32_32x32x32_bf16 v[240:255], v[176:179], v[208:215], v7
  v_exp_f32 v218, v218
  v_exp_f32 v219, v219
  v_exp_f32 v220, v220
  v_exp_f32 v221, v221
  v_exp_f32 v222, v222
  v_exp_f32 v223, v223
  v_exp_f32 v192, v192
  v_exp_f32 v193, v193
  v_smfmac_f32_32x32x32_bf16 v[240:255], v[180:183], v[216:223], v7
  v_exp_f32 v194, v194
  v_exp_f32 v195, v195
  v_exp_f32 v196, v196
  v_mfma_f32_32x32x16_bf16 v[208:223], v[36:39], v[12:15], 0
  s_waitcnt vmcnt(0)
  v_and_b32 v6, 0x1ffff, v6
  v_and_b32 v171, 0x1ffff, v171
  ds_read_b64_tr_b16 v[88:89], v6 offset:0
  ds_read_b64_tr_b16 v[90:91], v6 offset:1024
  ds_read_b64_tr_b16 v[92:93], v171 offset:0
  ds_read_b64_tr_b16 v[94:95], v171 offset:1024
  v_exp_f32 v197, v197
  v_exp_f32 v198, v198
  v_exp_f32 v199, v199
  v_exp_f32 v200, v200
  v_exp_f32 v201, v201
  v_smfmac_f32_32x32x32_bf16 v[224:239], v[184:187], v[192:199], v7
  ds_read_b64_tr_b16 v[96:97], v6 offset:2048
  ds_read_b64_tr_b16 v[98:99], v6 offset:3072
  ds_read_b64_tr_b16 v[100:101], v171 offset:2048
  ds_read_b64_tr_b16 v[102:103], v171 offset:3072
  v_exp_f32 v202, v202
  v_exp_f32 v203, v203
  v_exp_f32 v204, v204
  v_exp_f32 v205, v205
  v_exp_f32 v206, v206
  v_exp_f32 v207, v207
  v_exp_f32 v208, v208
  v_exp_f32 v209, v209
  v_smfmac_f32_32x32x32_bf16 v[224:239], v[188:191], v[200:207], v7
  v_exp_f32 v210, v210
  v_exp_f32 v211, v211
  v_exp_f32 v212, v212
  v_exp_f32 v213, v213
  v_exp_f32 v214, v214
  v_exp_f32 v215, v215
  v_exp_f32 v216, v216
  v_exp_f32 v217, v217
  v_smfmac_f32_32x32x32_bf16 v[240:255], v[184:187], v[208:215], v7
  v_exp_f32 v218, v218
  v_exp_f32 v219, v219
  v_exp_f32 v220, v220
  v_exp_f32 v221, v221
  v_exp_f32 v222, v222
  v_exp_f32 v223, v223
  s_nop 1
  v_smfmac_f32_32x32x32_bf16 v[240:255], v[188:191], v[216:223], v7
  s_nop 11
  v_pk_add_f32 v[196:197], v[224:225], v[226:227]
  v_pk_add_f32 v[198:199], v[228:229], v[230:231]
  v_pk_add_f32 v[200:201], v[240:241], v[242:243]
  v_pk_add_f32 v[202:203], v[244:245], v[246:247]
  v_pk_add_f32 v[196:197], v[196:197], v[198:199]
  v_pk_add_f32 v[200:201], v[200:201], v[202:203]
  v_add_f32 v192, v196, v197
  v_add_f32 v193, v200, v201
  s_mov_b32 s60, 0x33800000
  s_mov_b32 s61, 0x5f800000
  s_movk_i32 s62, 0x207
  v_cmp_class_f32 s[94:95], v192, s62
  v_cmp_class_f32 s[96:97], v193, s62
  v_cmp_nge_f32 s[4:5], v232, s60
  v_cmp_nge_f32 s[6:7], v248, s60
  v_cmp_nlt_f32 s[28:29], v232, s61
  v_cmp_nlt_f32 s[30:31], v248, s61
  v_mul_f32 v168, s37, v168
  v_mul_f32 v169, s37, v169
  v_exp_f32 v168, v168
  v_exp_f32 v169, v169
  s_or_b64 s[94:95], s[94:95], s[96:97]
  s_or_b64 s[4:5], s[4:5], s[6:7]
  s_or_b64 s[28:29], s[28:29], s[30:31]
  s_or_b64 s[94:95], s[94:95], s[4:5]
  s_or_b64 s[94:95], s[94:95], s[28:29]
  s_cbranch_scc1 L_SLOW
L_OSTORE:
  v_fma_f32 v194, v168, v232, v232
  v_fma_f32 v195, v169, v248, v248
  v_rcp_f32 v194, v194
  v_rcp_f32 v195, v195
  s_mov_b32 s60, -2
  v_pk_mul_f32 v[224:225], v[224:225], v[194:195] op_sel:[0,0] op_sel_hi:[1,0]
  v_pk_mul_f32 v[226:227], v[226:227], v[194:195] op_sel:[0,0] op_sel_hi:[1,0]
  v_pk_mul_f32 v[228:229], v[228:229], v[194:195] op_sel:[0,0] op_sel_hi:[1,0]
  v_pk_mul_f32 v[230:231], v[230:231], v[194:195] op_sel:[0,0] op_sel_hi:[1,0]
  v_cvt_pk_bf16_f32 v32, v224, v225
  v_cvt_pk_bf16_f32 v33, v226, v227
  v_cvt_pk_bf16_f32 v34, v228, v229
  v_cvt_pk_bf16_f32 v35, v230, v231
  v_min_u32 v32, s60, v32
  v_min_u32 v33, s60, v33
  v_min_u32 v34, s60, v34
  v_min_u32 v35, s60, v35
  buffer_store_dwordx4 v[32:35], v4, s[12:15], s98 offen offset:0 sc1
  v_pk_mul_f32 v[240:241], v[240:241], v[194:195] op_sel:[0,1] op_sel_hi:[1,1]
  v_pk_mul_f32 v[242:243], v[242:243], v[194:195] op_sel:[0,1] op_sel_hi:[1,1]
  v_pk_mul_f32 v[244:245], v[244:245], v[194:195] op_sel:[0,1] op_sel_hi:[1,1]
  v_pk_mul_f32 v[246:247], v[246:247], v[194:195] op_sel:[0,1] op_sel_hi:[1,1]
  v_cvt_pk_bf16_f32 v36, v240, v241
  v_cvt_pk_bf16_f32 v37, v242, v243
  v_cvt_pk_bf16_f32 v38, v244, v245
  v_cvt_pk_bf16_f32 v39, v246, v247
  v_min_u32 v36, s60, v36
  v_min_u32 v37, s60, v37
  v_min_u32 v38, s60, v38
  v_min_u32 v39, s60, v39
  buffer_store_dwordx4 v[36:39], v4, s[12:15], s98 offen offset:1024 sc1
  s_setprio 0
  s_cmp_eq_u32 s68, 0
  s_cbranch_scc0 L_BY0a
  s_barrier
  s_branch L_BY0
L_BY0a:
  s_barrier
L_BY0:
  buffer_load_dwordx4 v[104:107], v174, s[12:15], s42 offen sc1
  buffer_load_dwordx4 v[108:111], v175, s[12:15], s42 offen sc1
  buffer_load_dwordx4 v[112:115], v174, s[12:15], s43 offen sc1
  buffer_load_dwordx4 v[116:119], v175, s[12:15], s43 offen sc1
  buffer_load_dwordx4 v[120:123], v174, s[12:15], s44 offen sc1
  buffer_load_dwordx4 v[124:127], v175, s[12:15], s44 offen sc1
  buffer_load_dwordx4 v[128:131], v174, s[12:15], s45 offen sc1
  buffer_load_dwordx4 v[132:135], v175, s[12:15], s45 offen sc1
  s_cmp_lg_u32 s68, 0
  s_cbranch_scc1 L_WN
  buffer_load_dwordx4 v[136:139], v174, s[12:15], s50 offen sc1
  buffer_load_dwordx4 v[140:143], v175, s[12:15], s50 offen sc1
  buffer_load_dwordx4 v[144:147], v174, s[12:15], s51 offen sc1
  buffer_load_dwordx4 v[148:151], v175, s[12:15], s51 offen sc1
  buffer_load_dwordx4 v[152:155], v174, s[12:15], s52 offen sc1
  buffer_load_dwordx4 v[156:159], v175, s[12:15], s52 offen sc1
  buffer_load_dwordx4 v[160:163], v174, s[12:15], s53 offen sc1
  buffer_load_dwordx4 v[164:167], v175, s[12:15], s53 offen sc1
L_WN:
  s_mov_b32 s65, 524288
  s_lshl_b32 s60, s35, 6
  s_lshl_b32 s62, s68, 5
  s_add_u32 s60, s60, s62
  v_and_b32 v10, 31, v0
  v_add_u32 v10, s60, v10
  v_lshlrev_b32 v10, 10, v10
  v_lshrrev_b32 v11, 5, v0
  v_lshl_add_u32 v8, v11, 4, v10
  s_lshl_b32 s60, s56, 13
  s_add_u32 s60, s60, 32768
  v_add_u32 v9, s60, v4
  s_lshl_b32 s60, s56, 12
  s_add_u32 s60, s60, 131072
  v_add_u32 v10, s60, v4
  s_lshl_b32 s60, s56, 12
  s_add_u32 s60, s60, 0
  v_add_u32 v11, s60, v4
  s_xor_b32 s61, s56, 1
  s_lshl_b32 s60, s61, 13
  s_add_u32 s60, s60, 34816
  v_add_u32 v17, s60, v4
  s_xor_b32 s61, s56, 2
  s_lshl_b32 s60, s61, 13
  s_add_u32 s60, s60, 36864
  v_add_u32 v18, s60, v4
  s_xor_b32 s61, s56, 3
  s_lshl_b32 s60, s61, 13
  s_add_u32 s60, s60, 38912
  v_add_u32 v19, s60, v4
  s_xor_b32 s61, s56, 4
  s_lshl_b32 s60, s61, 12
  s_add_u32 s60, s60, 131072
  v_add_u32 v20, s60, v4
  s_xor_b32 s61, s56, 5
  s_lshl_b32 s60, s61, 12
  s_add_u32 s60, s60, 133120
  v_add_u32 v21, s60, v4
  s_xor_b32 s61, s56, 6
  s_lshl_b32 s60, s61, 12
  s_add_u32 s60, s60, 0
  v_add_u32 v22, s60, v4
  s_xor_b32 s61, s56, 7
  s_lshl_b32 s60, s61, 12
  s_add_u32 s60, s60, 2048
  v_add_u32 v23, s60, v4
  s_waitcnt lgkmcnt(0)
  s_cmp_lg_u32 s68, 0
  s_cbranch_scc1 L_BY1
  s_barrier
L_BY1:
  s_cmp_eq_u32 s68, 0
  s_cbranch_scc1 L_A0
  buffer_load_dwordx4 v[136:139], v174, s[12:15], s50 offen sc1
  buffer_load_dwordx4 v[140:143], v175, s[12:15], s50 offen sc1
L_A0:
  s_waitcnt vmcnt(8)
  v_max3_u32 v5, v104, v105, v106
  v_max3_u32 v31, v107, v108, v109
  v_max3_u32 v5, v5, v110, v111
  v_max_u32 v5, v5, v31
  v_cmp_eq_u32 vcc, -1, v5
  s_cbranch_vccnz L_X0
  v_mfma_f32_32x32x16_bf16 v[176:191], v[40:43], v[104:107], 0
  v_mfma_f32_32x32x16_bf16 v[192:207], v[44:47], v[104:107], 0
  v_mfma_f32_32x32x16_bf16 v[208:223], v[40:43], v[108:111], 0
  v_mfma_f32_32x32x16_bf16 v[224:239], v[44:47], v[108:111], 0
  s_cmp_eq_u32 s68, 0
  s_cbranch_scc1 L_A1
  buffer_load_dwordx4 v[144:147], v174, s[12:15], s51 offen sc1
  buffer_load_dwordx4 v[148:151], v175, s[12:15], s51 offen sc1
L_A1:
  s_waitcnt vmcnt(8)
  v_max3_u32 v5, v112, v113, v114
  v_max3_u32 v31, v115, v116, v117
  v_max3_u32 v5, v5, v118, v119
  v_max_u32 v5, v5, v31
  v_cmp_eq_u32 vcc, -1, v5
  s_cbranch_vccnz L_X1
  v_mfma_f32_32x32x16_bf16 v[176:191], v[48:51], v[112:115], v[176:191]
  v_mfma_f32_32x32x16_bf16 v[192:207], v[52:55], v[112:115], v[192:207]
  v_mfma_f32_32x32x16_bf16 v[208:223], v[48:51], v[116:119], v[208:223]
  v_mfma_f32_32x32x16_bf16 v[224:239], v[52:55], v[116:119], v[224:239]
  s_cmp_eq_u32 s68, 0
  s_cbranch_scc1 L_A2
  buffer_load_dwordx4 v[152:155], v174, s[12:15], s52 offen sc1
  buffer_load_dwordx4 v[156:159], v175, s[12:15], s52 offen sc1
L_A2:
  s_waitcnt vmcnt(8)
  v_max3_u32 v5, v120, v121, v122
  v_max3_u32 v31, v123, v124, v125
  v_max3_u32 v5, v5, v126, v127
  v_max_u32 v5, v5, v31
  v_cmp_eq_u32 vcc, -1, v5
  s_cbranch_vccnz L_X2
  v_mfma_f32_32x32x16_bf16 v[176:191], v[56:59], v[120:123], v[176:191]
  v_mfma_f32_32x32x16_bf16 v[192:207], v[60:63], v[120:123], v[192:207]
  v_mfma_f32_32x32x16_bf16 v[208:223], v[56:59], v[124:127], v[208:223]
  v_mfma_f32_32x32x16_bf16 v[224:239], v[60:63], v[124:127], v[224:239]
  s_cmp_eq_u32 s68, 0
  s_cbranch_scc1 L_A3
  buffer_load_dwordx4 v[160:163], v174, s[12:15], s53 offen sc1
  buffer_load_dwordx4 v[164:167], v175, s[12:15], s53 offen sc1
L_A3:
  s_waitcnt vmcnt(8)
  v_max3_u32 v5, v128, v129, v130
  v_max3_u32 v31, v131, v132, v133
  v_max3_u32 v5, v5, v134, v135
  v_max_u32 v5, v5, v31
  v_cmp_eq_u32 vcc, -1, v5
  s_cbranch_vccnz L_X3
  v_mfma_f32_32x32x16_bf16 v[176:191], v[64:67], v[128:131], v[176:191]
  v_mfma_f32_32x32x16_bf16 v[192:207], v[68:71], v[128:131], v[192:207]
  v_mfma_f32_32x32x16_bf16 v[208:223], v[64:67], v[132:135], v[208:223]
  v_mfma_f32_32x32x16_bf16 v[224:239], v[68:71], v[132:135], v[224:239]
L_A4:
  s_waitcnt vmcnt(6)
  v_max3_u32 v5, v136, v137, v138
  v_max3_u32 v31, v139, v140, v141
  v_max3_u32 v5, v5, v142, v143
  v_max_u32 v5, v5, v31
  v_cmp_eq_u32 vcc, -1, v5
  s_cbranch_vccnz L_X4
  v_mfma_f32_32x32x16_bf16 v[176:191], v[72:75], v[136:139], v[176:191]
  v_mfma_f32_32x32x16_bf16 v[192:207], v[76:79], v[136:139], v[192:207]
  v_mfma_f32_32x32x16_bf16 v[208:223], v[72:75], v[140:143], v[208:223]
  v_mfma_f32_32x32x16_bf16 v[224:239], v[76:79], v[140:143], v[224:239]
L_A5:
  s_waitcnt vmcnt(4)
  v_max3_u32 v5, v144, v145, v146
  v_max3_u32 v31, v147, v148, v149
  v_max3_u32 v5, v5, v150, v151
  v_max_u32 v5, v5, v31
  v_cmp_eq_u32 vcc, -1, v5
  s_cbranch_vccnz L_X5
  v_mfma_f32_32x32x16_bf16 v[176:191], v[80:83], v[144:147], v[176:191]
  v_mfma_f32_32x32x16_bf16 v[192:207], v[84:87], v[144:147], v[192:207]
  v_mfma_f32_32x32x16_bf16 v[208:223], v[80:83], v[148:151], v[208:223]
  v_mfma_f32_32x32x16_bf16 v[224:239], v[84:87], v[148:151], v[224:239]
L_A6:
  s_waitcnt vmcnt(2)
  v_max3_u32 v5, v152, v153, v154
  v_max3_u32 v31, v155, v156, v157
  v_max3_u32 v5, v5, v158, v159
  v_max_u32 v5, v5, v31
  v_cmp_eq_u32 vcc, -1, v5
  s_cbranch_vccnz L_X6
  v_mfma_f32_32x32x16_bf16 v[176:191], v[88:91], v[152:155], v[176:191]
  v_mfma_f32_32x32x16_bf16 v[192:207], v[92:95], v[152:155], v[192:207]
  v_mfma_f32_32x32x16_bf16 v[208:223], v[88:91], v[156:159], v[208:223]
  v_mfma_f32_32x32x16_bf16 v[224:239], v[92:95], v[156:159], v[224:239]
L_A7:
  s_waitcnt vmcnt(0)
  v_max3_u32 v5, v160, v161, v162
  v_max3_u32 v31, v163, v164, v165
  v_max3_u32 v5, v5, v166, v167
  v_max_u32 v5, v5, v31
  v_cmp_eq_u32 vcc, -1, v5
  s_cbranch_vccnz L_X7
  v_mfma_f32_32x32x16_bf16 v[176:191], v[96:99], v[160:163], v[176:191]
  v_mfma_f32_32x32x16_bf16 v[192:207], v[100:103], v[160:163], v[192:207]
  v_mfma_f32_32x32x16_bf16 v[208:223], v[96:99], v[164:167], v[208:223]
  v_mfma_f32_32x32x16_bf16 v[224:239], v[100:103], v[164:167], v[224:239]
L_P3DONE:
  s_nop 11
  ds_write_b128 v9, v[184:187] offset:2048
  ds_write_b128 v9, v[188:191] offset:3072
  ds_write_b128 v9, v[192:195] offset:4096
  ds_write_b128 v9, v[196:199] offset:5120
  ds_write_b128 v9, v[200:203] offset:6144
  ds_write_b128 v9, v[204:207] offset:7168
  ds_write_b128 v10, v[208:211] offset:0
  ds_write_b128 v10, v[212:215] offset:1024
  ds_write_b128 v10, v[216:219] offset:2048
  ds_write_b128 v10, v[220:223] offset:3072
  ds_write_b128 v11, v[224:227] offset:0
  ds_write_b128 v11, v[228:231] offset:1024
  ds_write_b128 v11, v[232:235] offset:2048
  ds_write_b128 v11, v[236:239] offset:3072
  s_waitcnt lgkmcnt(0)
  s_barrier
  ds_read_b128 v[104:107], v17 offset:0
  ds_read_b128 v[108:111], v17 offset:1024
  ds_read_b128 v[112:115], v18 offset:0
  ds_read_b128 v[116:119], v18 offset:1024
  ds_read_b128 v[120:123], v19 offset:0
  ds_read_b128 v[124:127], v19 offset:1024
  ds_read_b128 v[128:131], v20 offset:0
  ds_read_b128 v[132:135], v20 offset:1024
  ds_read_b128 v[136:139], v21 offset:0
  ds_read_b128 v[140:143], v21 offset:1024
  ds_read_b128 v[144:147], v22 offset:0
  ds_read_b128 v[148:151], v22 offset:1024
  ds_read_b128 v[152:155], v23 offset:0
  ds_read_b128 v[156:159], v23 offset:1024
  s_waitcnt lgkmcnt(10)
  v_add_f32 v176, v176, v104
  v_add_f32 v177, v177, v105
  v_add_f32 v178, v178, v106
  v_add_f32 v179, v179, v107
  v_add_f32 v180, v180, v108
  v_add_f32 v181, v181, v109
  v_add_f32 v182, v182, v110
  v_add_f32 v183, v183, v111
  s_waitcnt lgkmcnt(8)
  v_add_f32 v176, v176, v112
  v_add_f32 v177, v177, v113
  v_add_f32 v178, v178, v114
  v_add_f32 v179, v179, v115
  v_add_f32 v180, v180, v116
  v_add_f32 v181, v181, v117
  v_add_f32 v182, v182, v118
  v_add_f32 v183, v183, v119
  s_waitcnt lgkmcnt(4)
  v_add_f32 v120, v120, v128
  v_add_f32 v121, v121, v129
  v_add_f32 v122, v122, v130
  v_add_f32 v123, v123, v131
  v_add_f32 v124, v124, v132
  v_add_f32 v125, v125, v133
  v_add_f32 v126, v126, v134
  v_add_f32 v127, v127, v135
  v_add_f32 v176, v176, v120
  v_add_f32 v177, v177, v121
  v_add_f32 v178, v178, v122
  v_add_f32 v179, v179, v123
  v_add_f32 v180, v180, v124
  v_add_f32 v181, v181, v125
  v_add_f32 v182, v182, v126
  v_add_f32 v183, v183, v127
  s_waitcnt lgkmcnt(0)
  v_add_f32 v136, v136, v144
  v_add_f32 v137, v137, v145
  v_add_f32 v138, v138, v146
  v_add_f32 v139, v139, v147
  v_add_f32 v140, v140, v148
  v_add_f32 v141, v141, v149
  v_add_f32 v142, v142, v150
  v_add_f32 v143, v143, v151
  v_add_f32 v176, v176, v152
  v_add_f32 v177, v177, v153
  v_add_f32 v178, v178, v154
  v_add_f32 v179, v179, v155
  v_add_f32 v180, v180, v156
  v_add_f32 v181, v181, v157
  v_add_f32 v182, v182, v158
  v_add_f32 v183, v183, v159
  v_add_f32 v176, v176, v136
  v_add_f32 v177, v177, v137
  v_add_f32 v178, v178, v138
  v_add_f32 v179, v179, v139
  v_add_f32 v180, v180, v140
  v_add_f32 v181, v181, v141
  v_add_f32 v182, v182, v142
  v_add_f32 v183, v183, v143
  v_cvt_pk_bf16_f32 v32, v176, v177
  v_cvt_pk_bf16_f32 v33, v178, v179
  v_cvt_pk_bf16_f32 v34, v180, v181
  v_cvt_pk_bf16_f32 v35, v182, v183
  buffer_store_dwordx4 v[32:35], v8, s[24:27], s36 offen
L_END:
  s_endpgm
L_GCX:
  s_mov_b32 s65, 524288
L_GC_P:
  s_sub_u32 s65, s65, 1
  s_cbranch_scc1 L_GC_OK
  s_sleep 2
  buffer_load_dword v5, v31, s[12:15], s62 offen sc1
  buffer_load_dword v173, v31, s[12:15], s1 offen sc1
  s_waitcnt vmcnt(0)
  v_min_u32 v5, v5, v173
  v_cmp_gt_u32 vcc, 64, v5
  s_nop 1
  s_and_b64 vcc, vcc, exec
  s_cbranch_scc1 L_GC_P
L_GC_OK:
  s_branch L_GCX_R
L_X0:
  buffer_load_dwordx4 v[104:107], v174, s[12:15], s42 offen sc1
  buffer_load_dwordx4 v[108:111], v175, s[12:15], s42 offen sc1
  s_mov_b32 s101, 0
  s_waitcnt vmcnt(2)
  s_branch L_B1
L_X1:
  buffer_load_dwordx4 v[112:115], v174, s[12:15], s43 offen sc1
  buffer_load_dwordx4 v[116:119], v175, s[12:15], s43 offen sc1
  s_mov_b32 s101, 1
  s_waitcnt vmcnt(2)
  s_branch L_B2
L_X2:
  buffer_load_dwordx4 v[120:123], v174, s[12:15], s44 offen sc1
  buffer_load_dwordx4 v[124:127], v175, s[12:15], s44 offen sc1
  s_mov_b32 s101, 2
  s_waitcnt vmcnt(2)
  s_branch L_B3
L_X3:
  buffer_load_dwordx4 v[128:131], v174, s[12:15], s45 offen sc1
  buffer_load_dwordx4 v[132:135], v175, s[12:15], s45 offen sc1
  s_mov_b32 s101, 3
  s_waitcnt vmcnt(2)
  s_branch L_B4
L_X4:
  buffer_load_dwordx4 v[136:139], v174, s[12:15], s50 offen sc1
  buffer_load_dwordx4 v[140:143], v175, s[12:15], s50 offen sc1
  s_mov_b32 s101, 4
  s_waitcnt vmcnt(2)
  s_branch L_B5
L_X5:
  buffer_load_dwordx4 v[144:147], v174, s[12:15], s51 offen sc1
  buffer_load_dwordx4 v[148:151], v175, s[12:15], s51 offen sc1
  s_mov_b32 s101, 5
  s_waitcnt vmcnt(2)
  s_branch L_B6
L_X6:
  buffer_load_dwordx4 v[152:155], v174, s[12:15], s52 offen sc1
  buffer_load_dwordx4 v[156:159], v175, s[12:15], s52 offen sc1
  s_mov_b32 s101, 6
  s_waitcnt vmcnt(2)
  s_branch L_B7
L_X7:
  buffer_load_dwordx4 v[160:163], v174, s[12:15], s53 offen sc1
  buffer_load_dwordx4 v[164:167], v175, s[12:15], s53 offen sc1
  s_mov_b32 s101, 7
  s_waitcnt vmcnt(2)
  s_branch L_B8
L_B1:
  v_max3_u32 v5, v112, v113, v114
  v_max3_u32 v31, v115, v116, v117
  v_max3_u32 v5, v5, v118, v119
  v_max_u32 v5, v5, v31
  v_cmp_eq_u32 vcc, -1, v5
  s_cbranch_vccnz L_Y1
L_B2:
  v_max3_u32 v5, v120, v121, v122
  v_max3_u32 v31, v123, v124, v125
  v_max3_u32 v5, v5, v126, v127
  v_max_u32 v5, v5, v31
  v_cmp_eq_u32 vcc, -1, v5
  s_cbranch_vccnz L_Y2
L_B3:
  v_max3_u32 v5, v128, v129, v130
  v_max3_u32 v31, v131, v132, v133
  v_max3_u32 v5, v5, v134, v135
  v_max_u32 v5, v5, v31
  v_cmp_eq_u32 vcc, -1, v5
  s_cbranch_vccnz L_Y3
L_B4:
  v_max3_u32 v5, v136, v137, v138
  v_max3_u32 v31, v139, v140, v141
  v_max3_u32 v5, v5, v142, v143
  v_max_u32 v5, v5, v31
  v_cmp_eq_u32 vcc, -1, v5
  s_cbranch_vccnz L_Y4
L_B5:
  v_max3_u32 v5, v144, v145, v146
  v_max3_u32 v31, v147, v148, v149
  v_max3_u32 v5, v5, v150, v151
  v_max_u32 v5, v5, v31
  v_cmp_eq_u32 vcc, -1, v5
  s_cbranch_vccnz L_Y5
L_B6:
  v_max3_u32 v5, v152, v153, v154
  v_max3_u32 v31, v155, v156, v157
  v_max3_u32 v5, v5, v158, v159
  v_max_u32 v5, v5, v31
  v_cmp_eq_u32 vcc, -1, v5
  s_cbranch_vccnz L_Y6
L_B7:
  v_max3_u32 v5, v160, v161, v162
  v_max3_u32 v31, v163, v164, v165
  v_max3_u32 v5, v5, v166, v167
  v_max_u32 v5, v5, v31
  v_cmp_eq_u32 vcc, -1, v5
  s_cbranch_vccnz L_Y7
L_B8:
  s_sub_u32 s65, s65, 1
  s_cbranch_scc1 L_P3DONE
  s_sleep 4
  s_waitcnt vmcnt(0)
  s_cmp_eq_u32 s101, 7
  s_cbranch_scc1 L_A7
  s_cmp_eq_u32 s101, 6
  s_cbranch_scc1 L_A6
  s_cmp_eq_u32 s101, 5
  s_cbranch_scc1 L_A5
  s_cmp_eq_u32 s101, 4
  s_cbranch_scc1 L_A4
  s_cmp_eq_u32 s101, 3
  s_cbranch_scc1 L_A3
  s_cmp_eq_u32 s101, 2
  s_cbranch_scc1 L_A2
  s_cmp_eq_u32 s101, 1
  s_cbranch_scc1 L_A1
  s_branch L_A0
L_Y1:
  buffer_load_dwordx4 v[112:115], v174, s[12:15], s43 offen sc1
  buffer_load_dwordx4 v[116:119], v175, s[12:15], s43 offen sc1
  s_branch L_B2
L_Y2:
  buffer_load_dwordx4 v[120:123], v174, s[12:15], s44 offen sc1
  buffer_load_dwordx4 v[124:127], v175, s[12:15], s44 offen sc1
  s_branch L_B3
L_Y3:
  buffer_load_dwordx4 v[128:131], v174, s[12:15], s45 offen sc1
  buffer_load_dwordx4 v[132:135], v175, s[12:15], s45 offen sc1
  s_branch L_B4
L_Y4:
  buffer_load_dwordx4 v[136:139], v174, s[12:15], s50 offen sc1
  buffer_load_dwordx4 v[140:143], v175, s[12:15], s50 offen sc1
  s_branch L_B5
L_Y5:
  buffer_load_dwordx4 v[144:147], v174, s[12:15], s51 offen sc1
  buffer_load_dwordx4 v[148:151], v175, s[12:15], s51 offen sc1
  s_branch L_B6
L_Y6:
  buffer_load_dwordx4 v[152:155], v174, s[12:15], s52 offen sc1
  buffer_load_dwordx4 v[156:159], v175, s[12:15], s52 offen sc1
  s_branch L_B7
L_Y7:
  buffer_load_dwordx4 v[160:163], v174, s[12:15], s53 offen sc1
  buffer_load_dwordx4 v[164:167], v175, s[12:15], s53 offen sc1
  s_branch L_B8
L_SLOW:
  v_and_b32 v172, 0x3fff, v3
  v_mov_b32 v5, 0xff800000
  s_mov_b32 s60, s100
  s_mov_b32 s61, 64
L_SM0:
  buffer_load_dwordx4 v[32:35], v4, s[12:15], s60 offen sc1
  s_waitcnt vmcnt(0)
  v_mfma_f32_32x32x16_bf16 v[192:207], v[32:35], v[8:11], 0
  s_nop 15
  v_max3_f32 v5, v192, v193, v5
  v_max3_f32 v5, v194, v195, v5
  v_max3_f32 v5, v196, v197, v5
  v_max3_f32 v5, v198, v199, v5
  v_max3_f32 v5, v200, v201, v5
  v_max3_f32 v5, v202, v203, v5
  v_max3_f32 v5, v204, v205, v5
  v_max3_f32 v5, v206, v207, v5
  s_add_u32 s60, s60, 2048
  s_sub_u32 s61, s61, 1
  s_cmp_lg_u32 s61, 0
  s_cbranch_scc1 L_SM0
  v_mov_b32 v1, v5
  s_nop 1
  v_permlane32_swap_b32 v1, v5
  s_nop 1
  v_max_f32 v5, v1, v5
  v_sub_f32 v208, 0, v5
  v_sub_f32 v209, 0, v5
  v_sub_f32 v210, 0, v5
  v_sub_f32 v211, 0, v5
  v_sub_f32 v212, 0, v5
  v_sub_f32 v213, 0, v5
  v_sub_f32 v214, 0, v5
  v_sub_f32 v215, 0, v5
  v_sub_f32 v216, 0, v5
  v_sub_f32 v217, 0, v5
  v_sub_f32 v218, 0, v5
  v_sub_f32 v219, 0, v5
  v_sub_f32 v220, 0, v5
  v_sub_f32 v221, 0, v5
  v_sub_f32 v222, 0, v5
  v_sub_f32 v223, 0, v5
  v_mov_b32 v224, 0
  v_mov_b32 v225, 0
  v_mov_b32 v226, 0
  v_mov_b32 v227, 0
  v_mov_b32 v228, 0
  v_mov_b32 v229, 0
  v_mov_b32 v230, 0
  v_mov_b32 v231, 0
  v_mov_b32 v232, 0
  v_mov_b32 v233, 0
  v_mov_b32 v234, 0
  v_mov_b32 v235, 0
  v_mov_b32 v236, 0
  v_mov_b32 v237, 0
  v_mov_b32 v238, 0
  v_mov_b32 v239, 0
  s_mov_b32 s60, s100
  s_mov_b32 s61, 64
L_SP0:
  buffer_load_dwordx4 v[32:35], v4, s[12:15], s60 offen sc1
  s_mov_b64 exec, s[66:67]
  buffer_load_dwordx4 v[176:179], v172, s[12:15], s60 offen sc1
  buffer_load_dwordx4 v[180:183], v172, s[12:15], s60 offen offset:512 sc1
  s_mov_b64 exec, -1
  s_waitcnt vmcnt(0)
  v_mfma_f32_32x32x16_bf16 v[192:207], v[32:35], v[8:11], v[208:223]
  s_nop 15
  v_exp_f32 v192, v192
  v_exp_f32 v193, v193
  v_exp_f32 v194, v194
  v_exp_f32 v195, v195
  v_exp_f32 v196, v196
  v_exp_f32 v197, v197
  v_exp_f32 v198, v198
  v_exp_f32 v199, v199
  v_exp_f32 v200, v200
  v_exp_f32 v201, v201
  v_exp_f32 v202, v202
  v_exp_f32 v203, v203
  v_exp_f32 v204, v204
  v_exp_f32 v205, v205
  v_exp_f32 v206, v206
  v_exp_f32 v207, v207
  s_nop 1
  v_smfmac_f32_32x32x32_bf16 v[224:239], v[176:179], v[192:199], v7
  v_smfmac_f32_32x32x32_bf16 v[224:239], v[180:183], v[200:207], v7
  s_add_u32 s60, s60, 2048
  s_sub_u32 s61, s61, 1
  s_cmp_lg_u32 s61, 0
  s_nop 15
  s_cbranch_scc1 L_SP0
  v_mov_b32 v5, 0xff800000
  s_mov_b32 s60, s100
  s_mov_b32 s61, 64
L_SM1:
  buffer_load_dwordx4 v[32:35], v4, s[12:15], s60 offen sc1
  s_waitcnt vmcnt(0)
  v_mfma_f32_32x32x16_bf16 v[192:207], v[32:35], v[12:15], 0
  s_nop 15
  v_max3_f32 v5, v192, v193, v5
  v_max3_f32 v5, v194, v195, v5
  v_max3_f32 v5, v196, v197, v5
  v_max3_f32 v5, v198, v199, v5
  v_max3_f32 v5, v200, v201, v5
  v_max3_f32 v5, v202, v203, v5
  v_max3_f32 v5, v204, v205, v5
  v_max3_f32 v5, v206, v207, v5
  s_add_u32 s60, s60, 2048
  s_sub_u32 s61, s61, 1
  s_cmp_lg_u32 s61, 0
  s_cbranch_scc1 L_SM1
  v_mov_b32 v1, v5
  s_nop 1
  v_permlane32_swap_b32 v1, v5
  s_nop 1
  v_max_f32 v5, v1, v5
  v_sub_f32 v208, 0, v5
  v_sub_f32 v209, 0, v5
  v_sub_f32 v210, 0, v5
  v_sub_f32 v211, 0, v5
  v_sub_f32 v212, 0, v5
  v_sub_f32 v213, 0, v5
  v_sub_f32 v214, 0, v5
  v_sub_f32 v215, 0, v5
  v_sub_f32 v216, 0, v5
  v_sub_f32 v217, 0, v5
  v_sub_f32 v218, 0, v5
  v_sub_f32 v219, 0, v5
  v_sub_f32 v220, 0, v5
  v_sub_f32 v221, 0, v5
  v_sub_f32 v222, 0, v5
  v_sub_f32 v223, 0, v5
  v_mov_b32 v240, 0
  v_mov_b32 v241, 0
  v_mov_b32 v242, 0
  v_mov_b32 v243, 0
  v_mov_b32 v244, 0
  v_mov_b32 v245, 0
  v_mov_b32 v246, 0
  v_mov_b32 v247, 0
  v_mov_b32 v248, 0
  v_mov_b32 v249, 0
  v_mov_b32 v250, 0
  v_mov_b32 v251, 0
  v_mov_b32 v252, 0
  v_mov_b32 v253, 0
  v_mov_b32 v254, 0
  v_mov_b32 v255, 0
  s_mov_b32 s60, s100
  s_mov_b32 s61, 64
L_SP1:
  buffer_load_dwordx4 v[32:35], v4, s[12:15], s60 offen sc1
  s_mov_b64 exec, s[66:67]
  buffer_load_dwordx4 v[176:179], v172, s[12:15], s60 offen sc1
  buffer_load_dwordx4 v[180:183], v172, s[12:15], s60 offen offset:512 sc1
  s_mov_b64 exec, -1
  s_waitcnt vmcnt(0)
  v_mfma_f32_32x32x16_bf16 v[192:207], v[32:35], v[12:15], v[208:223]
  s_nop 15
  v_exp_f32 v192, v192
  v_exp_f32 v193, v193
  v_exp_f32 v194, v194
  v_exp_f32 v195, v195
  v_exp_f32 v196, v196
  v_exp_f32 v197, v197
  v_exp_f32 v198, v198
  v_exp_f32 v199, v199
  v_exp_f32 v200, v200
  v_exp_f32 v201, v201
  v_exp_f32 v202, v202
  v_exp_f32 v203, v203
  v_exp_f32 v204, v204
  v_exp_f32 v205, v205
  v_exp_f32 v206, v206
  v_exp_f32 v207, v207
  s_nop 1
  v_smfmac_f32_32x32x32_bf16 v[240:255], v[176:179], v[192:199], v7
  v_smfmac_f32_32x32x32_bf16 v[240:255], v[180:183], v[200:207], v7
  s_add_u32 s60, s60, 2048
  s_sub_u32 s61, s61, 1
  s_cmp_lg_u32 s61, 0
  s_nop 15
  s_cbranch_scc1 L_SP1
  s_branch L_OSTORE
L_CODEEND:
.section .rodata,"a"
.p2align 6
.amdhsa_kernel gated_mix__softmax_full_mha__mha_block__prompt_kernel
.amdhsa_next_free_vgpr 256
.amdhsa_next_free_sgpr 102
.amdhsa_accum_offset 256
.amdhsa_group_segment_fixed_size 0
.amdhsa_kernarg_size 80
.amdhsa_user_sgpr_count 2
.amdhsa_user_sgpr_kernarg_segment_ptr 1
.amdhsa_system_sgpr_workgroup_id_x 1
.amdhsa_float_denorm_mode_32 3
.end_amdhsa_kernel
```
